```python
import torch

def _softmax(x, axis=-1):
    return torch.softmax(x, dim=axis)

def _gelu(x):
    return torch.nn.functional.gelu(x, approximate='tanh')

def _silu(x):
    return torch.nn.functional.silu(x)

def _sigmoid(x):
    return torch.sigmoid(x)

def _layernorm(x, axis=-1, eps=1e-05):
    m = x.mean(dim=axis, keepdim=True)
    v = x.var(dim=axis, keepdim=True, unbiased=False)
    return (x - m) / torch.sqrt(v + eps)

def _scatter_add(tgt, idx, src, axis=0):
    return tgt.clone().index_add_(axis, idx, src)

def _segment_sum(src, seg, n):
    out = torch.zeros((n,) + src.shape[1:], dtype=src.dtype)
    return out.index_add_(0, seg, src)

def _pad(x, pw):
    flat = tuple((v for pair in reversed(pw) for v in pair))
    return torch.nn.functional.pad(x, flat)
kernel_name = 'standalone__conformer_conv_module__speech'

def setup_inputs():

    _w = lambda a: (lambda t: t.to(torch.bfloat16) if t.is_floating_point() else t)(torch.as_tensor(a))
    B, T, D, K = (2, 4000, 512, 31)
    return {'x': _w((lambda *s: torch.randn(*s, dtype=torch.bfloat16) * 0.2)(B, T, D)), 'w_pw1': _w((lambda *s: torch.randn(*s, dtype=torch.bfloat16) * 0.2)(D, 2 * D)), 'dw': _w((lambda *s: torch.randn(*s, dtype=torch.bfloat16) * 0.2)(K, D)), 'w_pw2': _w((lambda *s: torch.randn(*s, dtype=torch.bfloat16) * 0.05)(D, D))}

def reference(x, w_pw1, dw, w_pw2):
    B, T, D = x.shape
    K = dw.shape[0]
    h = x @ w_pw1
    a, b = (h[..., :D].clone(), h[..., D:].clone())
    h = a * _sigmoid(b)
    pad = K // 2
    hp = _pad(h, ((0, 0), (pad, pad), (0, 0)))
    out = torch.zeros_like(h)
    for i in range(K):
        out = out + hp[:, i:i + T, :] * dw[i][None, None, :]
    return _silu(out) @ w_pw2
```

```asm
; @launch grid=(256,1,1) block=(512,1,1) lds=163840
.amdgcn_target "amdgcn-amd-amdhsa--gfx950"
.text
.globl standalone__conformer_conv_module__speech_kernel
.p2align 8
.type standalone__conformer_conv_module__speech_kernel,@function
standalone__conformer_conv_module__speech_kernel:
L_start:
    s_cmp_ge_u32 s2, 256
    s_cbranch_scc1 L_end
    s_load_dwordx8 s[4:11], s[0:1], 0
    s_load_dwordx4 s[12:15], s[0:1], 32
    s_load_dwordx2 s[16:17], s[0:1], 48
    v_lshrrev_b32 v1, 6, v0
    v_and_b32 v2, 63, v0
    s_and_b32 s54, s2, 7
    v_readfirstlane_b32 s48, v1
    s_lshr_b32 s51, s2, 3
    s_and_b32 s49, s51, 7
    s_lshr_b32 s51, s51, 3
    s_lshl_b32 s50, s54, 2
    s_add_u32 s50, s50, s51
    s_lshr_b32 s55, s50, 4
    s_and_b32 s56, s50, 15
    s_mul_i32 s56, s56, 250
    s_sub_u32 s52, s56, 15
    s_mul_i32 s57, s55, 4096000
    s_add_u32 s53, s49, s50
    s_mov_b32 s22, 4096000
    s_mov_b32 s23, 0x20000
    s_mov_b32 s26, 1048576
    s_mov_b32 s27, 0x20000
    s_lshl_b32 s58, s49, 7
    s_and_b32 s18, s48, 3
    v_lshrrev_b32 v4, 4, v2
    v_and_b32 v6, 15, v2

    s_cmp_lt_u32 s48, 4
    s_cbranch_scc1 L_compute
    s_lshr_b32 s3, s18, 1
    s_lshl_b32 s3, s3, 2
    v_add_u32 v7, s3, v4
    v_lshlrev_b32 v7, 1, v7
    v_xor_b32 v7, v7, v6
    v_lshrrev_b32 v8, 3, v7
    v_and_b32 v9, 7, v7
    v_lshlrev_b32 v9, 4, v9
    v_lshl_add_u32 v9, v8, 10, v9
    v_lshl_add_u32 v9, v4, 11, v9
    v_add_u32 v9, s58, v9
    s_lshr_b32 s19, s51, 1
    s_mul_i32 s19, s19, 8
    s_add_u32 s19, s19, s18
    s_add_u32 s3, s19, 0
    s_and_b32 s3, s3, 15
    s_lshl_b32 s75, s3, 13
    v_add_u32 v25, s75, v9
    s_lshl_b32 s3, s3, 10
    s_add_u32 s54, s3, 36864
    s_add_u32 s3, s19, 4
    s_and_b32 s3, s3, 15
    s_lshl_b32 s75, s3, 13
    v_add_u32 v26, s75, v9
    s_lshl_b32 s3, s3, 10
    s_add_u32 s55, s3, 36864
    s_add_u32 s3, s19, 8
    s_and_b32 s3, s3, 15
    s_lshl_b32 s75, s3, 13
    v_add_u32 v27, s75, v9
    s_lshl_b32 s3, s3, 10
    s_add_u32 s73, s3, 36864
    s_add_u32 s3, s19, 12
    s_and_b32 s3, s3, 15
    s_lshl_b32 s75, s3, 13
    v_add_u32 v28, s75, v9
    s_lshl_b32 s3, s3, 10
    s_add_u32 s78, s3, 36864
    v_lshrrev_b32 v3, 3, v2
    v_and_b32 v5, 7, v2
    s_lshr_b32 s3, s49, 1
    s_mul_i32 s3, s3, 9
    s_add_u32 s79, s3, s18
    v_add_u32 v10, s52, v3
    s_lshl_b32 s3, s79, 2
    v_add_u32 v11, s3, v4
    v_and_b32 v11, 7, v11
    v_xor_b32 v11, v11, v5
    v_lshlrev_b32 v11, 4, v11
    v_lshl_add_u32 v10, v10, 10, v11
    s_add_u32 s3, s53, 0
    s_and_b32 s3, s3, 1
    s_lshl_b32 s69, s3, 17
    s_lshl_b32 s71, s3, 7
    s_waitcnt lgkmcnt(0)
    s_add_u32 s20, s4, s57
    s_addc_u32 s21, s5, 0
    s_mov_b32 s24, s6
    s_mov_b32 s25, s7

    s_add_u32 m0, s54, 0
    s_nop 0
    buffer_load_dwordx4 v25, s[24:27], s69 offen  lds
    s_add_u32 m0, s55, 0
    s_nop 0
    buffer_load_dwordx4 v26, s[24:27], s69 offen  lds
    s_lshl_b32 s60, s79, 10
    s_lshl_b32 s75, s79, 13
    s_cmp_eq_u32 s79, 35
    s_cselect_b32 s75, 0x40000000, s75
    v_add_u32 v16, s75, v10
    v_min_u32 v16, 0x80000000, v16
    s_add_u32 m0, s60, 0
    s_nop 0
    buffer_load_dwordx4 v16, s[20:23], s71 offen nt lds
    s_add_u32 s79, s79, 4
    s_sub_u32 s75, s79, 36
    s_cmp_ge_u32 s79, 36
    s_cselect_b32 s79, s75, s79
    s_lshl_b32 s61, s79, 10
    s_lshl_b32 s75, s79, 13
    s_cmp_eq_u32 s79, 35
    s_cselect_b32 s75, 0x40000000, s75
    v_add_u32 v17, s75, v10
    v_min_u32 v17, 0x80000000, v17
    s_add_u32 m0, s61, 0
    s_nop 0
    buffer_load_dwordx4 v17, s[20:23], s71 offen nt lds
    s_add_u32 s79, s79, 4
    s_sub_u32 s75, s79, 36
    s_cmp_ge_u32 s79, 36
    s_cselect_b32 s79, s75, s79
    s_lshl_b32 s62, s79, 10
    s_lshl_b32 s75, s79, 13
    s_cmp_eq_u32 s79, 35
    s_cselect_b32 s75, 0x40000000, s75
    v_add_u32 v18, s75, v10
    v_min_u32 v18, 0x80000000, v18
    s_add_u32 m0, s62, 0
    s_nop 0
    buffer_load_dwordx4 v18, s[20:23], s71 offen nt lds
    s_add_u32 s79, s79, 4
    s_sub_u32 s75, s79, 36
    s_cmp_ge_u32 s79, 36
    s_cselect_b32 s79, s75, s79
    s_lshl_b32 s63, s79, 10
    s_lshl_b32 s75, s79, 13
    s_cmp_eq_u32 s79, 35
    s_cselect_b32 s75, 0x40000000, s75
    v_add_u32 v19, s75, v10
    v_min_u32 v19, 0x80000000, v19
    s_add_u32 m0, s63, 0
    s_nop 0
    buffer_load_dwordx4 v19, s[20:23], s71 offen nt lds
    s_add_u32 s79, s79, 4
    s_sub_u32 s75, s79, 36
    s_cmp_ge_u32 s79, 36
    s_cselect_b32 s79, s75, s79
    s_lshl_b32 s64, s79, 10
    s_lshl_b32 s75, s79, 13
    s_cmp_eq_u32 s79, 35
    s_cselect_b32 s75, 0x40000000, s75
    v_add_u32 v20, s75, v10
    v_min_u32 v20, 0x80000000, v20
    s_add_u32 m0, s64, 0
    s_nop 0
    buffer_load_dwordx4 v20, s[20:23], s71 offen nt lds
    s_add_u32 s79, s79, 4
    s_sub_u32 s75, s79, 36
    s_cmp_ge_u32 s79, 36
    s_cselect_b32 s79, s75, s79
    s_lshl_b32 s65, s79, 10
    s_lshl_b32 s75, s79, 13
    s_cmp_eq_u32 s79, 35
    s_cselect_b32 s75, 0x40000000, s75
    v_add_u32 v21, s75, v10
    v_min_u32 v21, 0x80000000, v21
    s_add_u32 m0, s65, 0
    s_nop 0
    buffer_load_dwordx4 v21, s[20:23], s71 offen nt lds
    s_add_u32 s79, s79, 4
    s_sub_u32 s75, s79, 36
    s_cmp_ge_u32 s79, 36
    s_cselect_b32 s79, s75, s79
    s_lshl_b32 s66, s79, 10
    s_lshl_b32 s75, s79, 13
    s_cmp_eq_u32 s79, 35
    s_cselect_b32 s75, 0x40000000, s75
    v_add_u32 v22, s75, v10
    v_min_u32 v22, 0x80000000, v22
    s_add_u32 m0, s66, 0
    s_nop 0
    buffer_load_dwordx4 v22, s[20:23], s71 offen nt lds
    s_add_u32 s79, s79, 4
    s_sub_u32 s75, s79, 36
    s_cmp_ge_u32 s79, 36
    s_cselect_b32 s79, s75, s79
    s_lshl_b32 s67, s79, 10
    s_lshl_b32 s75, s79, 13
    s_cmp_eq_u32 s79, 35
    s_cselect_b32 s75, 0x40000000, s75
    v_add_u32 v23, s75, v10
    v_min_u32 v23, 0x80000000, v23
    s_add_u32 m0, s67, 0
    s_nop 0
    buffer_load_dwordx4 v23, s[20:23], s71 offen nt lds
    s_add_u32 s79, s79, 4
    s_sub_u32 s75, s79, 36
    s_cmp_ge_u32 s79, 36
    s_cselect_b32 s79, s75, s79
    s_lshl_b32 s68, s79, 10
    s_lshl_b32 s75, s79, 13
    s_cmp_eq_u32 s79, 35
    s_cselect_b32 s75, 0x40000000, s75
    v_add_u32 v24, s75, v10
    v_min_u32 v24, 0x80000000, v24
    s_add_u32 m0, s68, 0
    s_nop 0
    buffer_load_dwordx4 v24, s[20:23], s71 offen nt lds
    s_add_u32 m0, s73, 0
    s_nop 0
    buffer_load_dwordx4 v27, s[24:27], s69 offen  lds
    s_mov_b32 s28, s10
    s_mov_b32 s29, s11
    s_mov_b32 s30, 524288
    s_mov_b32 s31, 0x20000
    s_mov_b32 s32, s8
    s_mov_b32 s33, s9
    s_mov_b32 s34, 31744
    s_mov_b32 s35, 0x20000
    s_lshl_b32 s59, s56, 10
    s_add_u32 s59, s59, s57
    s_add_u32 s36, s12, s59
    s_addc_u32 s37, s13, 0
    s_mov_b32 s38, 256000
    s_mov_b32 s39, 0x20000
    s_mov_b32 s40, s16
    s_mov_b32 s41, s17
    s_mov_b32 s42, 0x8000000
    s_mov_b32 s43, 0x20000
    s_mov_b32 s44, s14
    s_mov_b32 s45, s15
    s_mov_b32 s46, 256
    s_mov_b32 s47, 0x20000
    s_mov_b32 s76, 0xbfb8aa3b
    s_mov_b32 s77, 0xbfb8aa3b
    s_and_b32 s19, s49, 6

    v_lshrrev_b32 v7, 1, v2
    v_and_b32 v8, 1, v2
    v_lshlrev_b32 v9, 10, v7
    v_lshl_add_u32 v9, v8, 3, v9
    s_lshl_b32 s3, s18, 4
    s_add_u32 s3, s3, s58
    v_add_u32 v30, s3, v9
    s_mul_i32 s3, s50, 524288
    s_add_u32 s3, s3, 262144
    v_lshlrev_b32 v39, 4, v5
    v_add_u32 v39, s3, v39
    s_and_b32 s3, s49, 1
    s_lshl_b32 s75, s51, 1
    s_add_u32 s3, s3, s75
    s_lshl_b32 s3, s3, 2
    s_add_u32 s3, s3, s18
    s_lshl_b32 s3, s3, 14
    s_lshl_b32 s75, s19, 7
    s_add_u32 s3, s3, s75
    v_lshlrev_b32 v9, 10, v7
    v_lshl_add_u32 v9, v8, 7, v9
    v_add_u32 v32, s3, v9
    s_lshl_b32 s3, s50, 3
    v_add_u32 v33, s3, v5
    v_cmp_eq_u32 s[80:81], s49, v2
    s_add_u32 m0, s78, 0
    s_nop 0
    buffer_load_dwordx4 v28, s[24:27], s69 offen  lds
    s_add_u32 s3, s53, 1
    s_and_b32 s3, s3, 1
    s_lshl_b32 s70, s3, 17
    s_lshl_b32 s72, s3, 7
    s_add_u32 m0, s54, 53248
    s_nop 0
    buffer_load_dwordx4 v25, s[24:27], s70 offen  lds
    s_add_u32 m0, s55, 53248
    s_nop 0
    buffer_load_dwordx4 v26, s[24:27], s70 offen  lds
    s_add_u32 m0, s60, 53248
    s_nop 0
    buffer_load_dwordx4 v16, s[20:23], s72 offen  lds
    s_add_u32 m0, s61, 53248
    s_nop 0
    buffer_load_dwordx4 v17, s[20:23], s72 offen  lds
    s_add_u32 m0, s62, 53248
    s_nop 0
    buffer_load_dwordx4 v18, s[20:23], s72 offen  lds
    s_add_u32 m0, s63, 53248
    s_nop 0
    buffer_load_dwordx4 v19, s[20:23], s72 offen  lds
    s_waitcnt vmcnt(6)
    s_barrier
    s_add_u32 m0, s64, 53248
    s_nop 0
    buffer_load_dwordx4 v20, s[20:23], s72 offen  lds
    s_add_u32 m0, s65, 53248
    s_nop 0
    buffer_load_dwordx4 v21, s[20:23], s72 offen  lds
    s_add_u32 m0, s66, 53248
    s_nop 0
    buffer_load_dwordx4 v22, s[20:23], s72 offen  lds
    s_add_u32 m0, s67, 53248
    s_nop 0
    buffer_load_dwordx4 v23, s[20:23], s72 offen  lds
    s_add_u32 m0, s68, 53248
    s_nop 0
    buffer_load_dwordx4 v24, s[20:23], s72 offen  lds
    s_add_u32 m0, s73, 53248
    s_nop 0
    buffer_load_dwordx4 v27, s[24:27], s70 offen  lds
    s_add_u32 m0, s78, 53248
    s_nop 0
    buffer_load_dwordx4 v28, s[24:27], s70 offen  lds
    s_add_u32 s3, s53, 2
    s_and_b32 s3, s3, 1
    s_add_u32 s3, s3, 2
    s_lshl_b32 s69, s3, 17
    s_lshl_b32 s71, s3, 7
    s_add_u32 m0, s54, 106496
    s_nop 0
    buffer_load_dwordx4 v25, s[24:27], s69 offen  lds
    s_add_u32 m0, s55, 106496
    s_nop 0
    buffer_load_dwordx4 v26, s[24:27], s69 offen  lds
    s_add_u32 m0, s60, 106496
    s_nop 0
    buffer_load_dwordx4 v16, s[20:23], s71 offen nt lds
    s_add_u32 m0, s61, 106496
    s_nop 0
    buffer_load_dwordx4 v17, s[20:23], s71 offen nt lds
    s_add_u32 m0, s62, 106496
    s_nop 0
    buffer_load_dwordx4 v18, s[20:23], s71 offen nt lds
    s_add_u32 m0, s63, 106496
    s_nop 0
    buffer_load_dwordx4 v19, s[20:23], s71 offen nt lds
    s_waitcnt vmcnt(6)
    s_barrier
    s_add_u32 m0, s64, 106496
    s_nop 0
    buffer_load_dwordx4 v20, s[20:23], s71 offen nt lds
    s_add_u32 m0, s65, 106496
    s_nop 0
    buffer_load_dwordx4 v21, s[20:23], s71 offen nt lds
    s_add_u32 m0, s66, 106496
    s_nop 0
    buffer_load_dwordx4 v22, s[20:23], s71 offen nt lds
    s_add_u32 m0, s67, 106496
    s_nop 0
    buffer_load_dwordx4 v23, s[20:23], s71 offen nt lds
    s_add_u32 m0, s68, 106496
    s_nop 0
    buffer_load_dwordx4 v24, s[20:23], s71 offen nt lds
    s_add_u32 m0, s73, 106496
    s_nop 0
    buffer_load_dwordx4 v27, s[24:27], s69 offen  lds
    s_add_u32 m0, s78, 106496
    s_nop 0
    buffer_load_dwordx4 v28, s[24:27], s69 offen  lds
    s_add_u32 s3, s53, 3
    s_and_b32 s3, s3, 1
    s_add_u32 s3, s3, 2
    s_lshl_b32 s70, s3, 17
    s_lshl_b32 s72, s3, 7
    s_add_u32 m0, s54, 0
    s_nop 0
    buffer_load_dwordx4 v25, s[24:27], s70 offen  lds
    s_add_u32 m0, s55, 0
    s_nop 0
    buffer_load_dwordx4 v26, s[24:27], s70 offen  lds
    s_add_u32 m0, s60, 0
    s_nop 0
    buffer_load_dwordx4 v16, s[20:23], s72 offen  lds
    s_add_u32 m0, s61, 0
    s_nop 0
    buffer_load_dwordx4 v17, s[20:23], s72 offen  lds
    s_add_u32 m0, s62, 0
    s_nop 0
    buffer_load_dwordx4 v18, s[20:23], s72 offen  lds
    s_add_u32 m0, s63, 0
    s_nop 0
    buffer_load_dwordx4 v19, s[20:23], s72 offen  lds
    s_add_u32 m0, s64, 0
    s_nop 0
    buffer_load_dwordx4 v20, s[20:23], s72 offen  lds
    s_add_u32 m0, s65, 0
    s_nop 0
    buffer_load_dwordx4 v21, s[20:23], s72 offen  lds
    s_add_u32 m0, s66, 0
    s_nop 0
    buffer_load_dwordx4 v22, s[20:23], s72 offen  lds
    s_add_u32 m0, s67, 0
    s_nop 0
    buffer_load_dwordx4 v23, s[20:23], s72 offen  lds
    s_add_u32 m0, s68, 0
    s_nop 0
    buffer_load_dwordx4 v24, s[20:23], s72 offen  lds
    s_add_u32 m0, s73, 0
    s_nop 0
    buffer_load_dwordx4 v27, s[24:27], s70 offen  lds
    s_add_u32 m0, s78, 0
    s_nop 0
    buffer_load_dwordx4 v28, s[24:27], s70 offen  lds
    s_mov_b64 exec, 0xff
    buffer_load_dwordx4 v[120:123], v39, s[40:43], 0 offen sc1
    s_mov_b64 exec, -1
    s_waitcnt vmcnt(14)
    s_barrier
    s_add_u32 s3, s53, 4
    s_and_b32 s3, s3, 1
    s_add_u32 s3, s3, 4
    s_lshl_b32 s69, s3, 17
    s_lshl_b32 s71, s3, 7
    s_add_u32 m0, s54, 53248
    s_nop 0
    buffer_load_dwordx4 v25, s[24:27], s69 offen  lds
    s_add_u32 m0, s55, 53248
    s_nop 0
    buffer_load_dwordx4 v26, s[24:27], s69 offen  lds
    s_add_u32 m0, s60, 53248
    s_nop 0
    buffer_load_dwordx4 v16, s[20:23], s71 offen nt lds
    s_add_u32 m0, s61, 53248
    s_nop 0
    buffer_load_dwordx4 v17, s[20:23], s71 offen nt lds
    s_add_u32 m0, s62, 53248
    s_nop 0
    buffer_load_dwordx4 v18, s[20:23], s71 offen nt lds
    s_add_u32 m0, s63, 53248
    s_nop 0
    buffer_load_dwordx4 v19, s[20:23], s71 offen nt lds
    s_add_u32 m0, s64, 53248
    s_nop 0
    buffer_load_dwordx4 v20, s[20:23], s71 offen nt lds
    s_add_u32 m0, s65, 53248
    s_nop 0
    buffer_load_dwordx4 v21, s[20:23], s71 offen nt lds
    s_add_u32 m0, s66, 53248
    s_nop 0
    buffer_load_dwordx4 v22, s[20:23], s71 offen nt lds
    s_add_u32 m0, s67, 53248
    s_nop 0
    buffer_load_dwordx4 v23, s[20:23], s71 offen nt lds
    s_add_u32 m0, s68, 53248
    s_nop 0
    buffer_load_dwordx4 v24, s[20:23], s71 offen nt lds
    s_add_u32 m0, s73, 53248
    s_nop 0
    buffer_load_dwordx4 v27, s[24:27], s69 offen  lds
    s_add_u32 m0, s78, 53248
    s_nop 0
    buffer_load_dwordx4 v28, s[24:27], s69 offen  lds
    s_waitcnt vmcnt(14)
    s_barrier
    s_add_u32 s3, s53, 5
    s_and_b32 s3, s3, 1
    s_add_u32 s3, s3, 4
    s_lshl_b32 s70, s3, 17
    s_lshl_b32 s72, s3, 7
    s_add_u32 m0, s54, 106496
    s_nop 0
    buffer_load_dwordx4 v25, s[24:27], s70 offen  lds
    s_add_u32 m0, s55, 106496
    s_nop 0
    buffer_load_dwordx4 v26, s[24:27], s70 offen  lds
    s_add_u32 m0, s60, 106496
    s_nop 0
    buffer_load_dwordx4 v16, s[20:23], s72 offen  lds
    s_add_u32 m0, s61, 106496
    s_nop 0
    buffer_load_dwordx4 v17, s[20:23], s72 offen  lds
    s_add_u32 m0, s62, 106496
    s_nop 0
    buffer_load_dwordx4 v18, s[20:23], s72 offen  lds
    s_add_u32 m0, s63, 106496
    s_nop 0
    buffer_load_dwordx4 v19, s[20:23], s72 offen  lds
    s_add_u32 m0, s64, 106496
    s_nop 0
    buffer_load_dwordx4 v20, s[20:23], s72 offen  lds
    s_add_u32 m0, s65, 106496
    s_nop 0
    buffer_load_dwordx4 v21, s[20:23], s72 offen  lds
    s_add_u32 m0, s66, 106496
    s_nop 0
    buffer_load_dwordx4 v22, s[20:23], s72 offen  lds
    s_add_u32 m0, s67, 106496
    s_nop 0
    buffer_load_dwordx4 v23, s[20:23], s72 offen  lds
    s_add_u32 m0, s68, 106496
    s_nop 0
    buffer_load_dwordx4 v24, s[20:23], s72 offen  lds
    s_add_u32 m0, s73, 106496
    s_nop 0
    buffer_load_dwordx4 v27, s[24:27], s70 offen  lds
    s_add_u32 m0, s78, 106496
    s_nop 0
    buffer_load_dwordx4 v28, s[24:27], s70 offen  lds
    buffer_load_dwordx2 v[34:35], v30, s[32:35], 0 offen
    buffer_load_dwordx2 v[36:37], v30, s[32:35], 0 offen offset:64
    s_waitcnt vmcnt(15)
    s_barrier
    s_add_u32 s3, s53, 6
    s_and_b32 s3, s3, 1
    s_add_u32 s3, s3, 6
    s_lshl_b32 s69, s3, 17
    s_lshl_b32 s71, s3, 7
    s_add_u32 m0, s54, 0
    s_nop 0
    buffer_load_dwordx4 v25, s[24:27], s69 offen  lds
    s_add_u32 m0, s55, 0
    s_nop 0
    buffer_load_dwordx4 v26, s[24:27], s69 offen  lds
    s_add_u32 m0, s60, 0
    s_nop 0
    buffer_load_dwordx4 v16, s[20:23], s71 offen nt lds
    s_add_u32 m0, s61, 0
    s_nop 0
    buffer_load_dwordx4 v17, s[20:23], s71 offen nt lds
    s_add_u32 m0, s62, 0
    s_nop 0
    buffer_load_dwordx4 v18, s[20:23], s71 offen nt lds
    s_add_u32 m0, s63, 0
    s_nop 0
    buffer_load_dwordx4 v19, s[20:23], s71 offen nt lds
    s_add_u32 m0, s64, 0
    s_nop 0
    buffer_load_dwordx4 v20, s[20:23], s71 offen nt lds
    s_add_u32 m0, s65, 0
    s_nop 0
    buffer_load_dwordx4 v21, s[20:23], s71 offen nt lds
    s_add_u32 m0, s66, 0
    s_nop 0
    buffer_load_dwordx4 v22, s[20:23], s71 offen nt lds
    s_add_u32 m0, s67, 0
    s_nop 0
    buffer_load_dwordx4 v23, s[20:23], s71 offen nt lds
    s_add_u32 m0, s68, 0
    s_nop 0
    buffer_load_dwordx4 v24, s[20:23], s71 offen nt lds
    s_add_u32 m0, s73, 0
    s_nop 0
    buffer_load_dwordx4 v27, s[24:27], s69 offen  lds
    s_add_u32 m0, s78, 0
    s_nop 0
    buffer_load_dwordx4 v28, s[24:27], s69 offen  lds
    s_waitcnt vmcnt(15)
    s_barrier
    s_add_u32 s3, s53, 7
    s_and_b32 s3, s3, 1
    s_add_u32 s3, s3, 6
    s_lshl_b32 s70, s3, 17
    s_lshl_b32 s72, s3, 7
    s_add_u32 m0, s54, 53248
    s_nop 0
    buffer_load_dwordx4 v25, s[24:27], s70 offen  lds
    s_add_u32 m0, s55, 53248
    s_nop 0
    buffer_load_dwordx4 v26, s[24:27], s70 offen  lds
    s_add_u32 m0, s60, 53248
    s_nop 0
    buffer_load_dwordx4 v16, s[20:23], s72 offen  lds
    s_add_u32 m0, s61, 53248
    s_nop 0
    buffer_load_dwordx4 v17, s[20:23], s72 offen  lds
    s_add_u32 m0, s62, 53248
    s_nop 0
    buffer_load_dwordx4 v18, s[20:23], s72 offen  lds
    s_add_u32 m0, s63, 53248
    s_nop 0
    buffer_load_dwordx4 v19, s[20:23], s72 offen  lds
    s_add_u32 m0, s64, 53248
    s_nop 0
    buffer_load_dwordx4 v20, s[20:23], s72 offen  lds
    s_add_u32 m0, s65, 53248
    s_nop 0
    buffer_load_dwordx4 v21, s[20:23], s72 offen  lds
    s_add_u32 m0, s66, 53248
    s_nop 0
    buffer_load_dwordx4 v22, s[20:23], s72 offen  lds
    s_add_u32 m0, s67, 53248
    s_nop 0
    buffer_load_dwordx4 v23, s[20:23], s72 offen  lds
    s_add_u32 m0, s68, 53248
    s_nop 0
    buffer_load_dwordx4 v24, s[20:23], s72 offen  lds
    s_add_u32 m0, s73, 53248
    s_nop 0
    buffer_load_dwordx4 v27, s[24:27], s70 offen  lds
    s_add_u32 m0, s78, 53248
    s_nop 0
    buffer_load_dwordx4 v28, s[24:27], s70 offen  lds
    s_mov_b64 exec, 0xffffffff
    buffer_load_dword v44, v32, s[28:31], 0 offen
    s_mov_b64 exec, -1
    s_getreg_b32 s3, hwreg(HW_REG_XCC_ID)
    s_and_b32 s3, s3, 15
    s_lshl_b32 s3, s3, 8
    s_add_u32 s3, s3, 1
    v_add_u32 v124, s3, v122
    s_mov_b64 exec, s[80:81]
    buffer_store_dword v124, v39, s[40:43], 0 offen offset:8
    s_mov_b64 exec, -1
    s_waitcnt vmcnt(15)
    s_barrier
    s_mul_i32 s3, s18, 768
    s_add_u32 s3, s3, 122880
    v_mul_u32_u24 v31, 384, v8
    v_lshl_add_u32 v31, v7, 1, v31
    v_add_u32 v31, s3, v31
    v_lshlrev_b32 v9, 4, v2
    v_add_u32 v29, s3, v9
    v_mov_b32 v48, 0
    v_mov_b32 v49, 0
    v_mov_b32 v50, 0
    v_mov_b32 v51, 0
    v_lshlrev_b32 v8, 3, v4
    v_sub_u32 v8, v8, v6
    v_add_u32 v8, 8, v8
    v_and_b32 v9, 1, v8
    v_mul_u32_u24 v9, 94, v9
    v_lshl_add_u32 v9, v8, 1, v9
    v_cmp_gt_u32 vcc, 39, v8
    s_nop 1
    v_cndmask_b32 v9, 0, v9, vcc
    v_add_u32 v42, s3, v9
    v_lshlrev_b32 v8, 3, v4
    v_sub_u32 v8, v8, v6
    v_add_u32 v8, 40, v8
    v_and_b32 v9, 1, v8
    v_mul_u32_u24 v9, 94, v9
    v_lshl_add_u32 v9, v8, 1, v9
    v_cmp_gt_u32 vcc, 39, v8
    s_nop 1
    v_cndmask_b32 v9, 0, v9, vcc
    v_add_u32 v43, s3, v9
    s_lshr_b32 s3, s18, 1
    s_lshl_b32 s3, s3, 2
    v_add_u32 v8, s3, v4
    v_lshlrev_b32 v8, 1, v8
    v_xor_b32 v8, v8, v6
    v_lshlrev_b32 v8, 4, v8
    s_lshl_b32 s3, s18, 2
    v_add_u32 v9, s3, v4
    v_lshl_add_u32 v8, v9, 10, v8
    s_lshl_b32 s3, s19, 7
    v_add_u32 v47, s3, v8
    s_lshl_b32 s74, s18, 10
    s_mul_i32 s3, s18, 4736
    s_add_u32 s3, s3, 125952
    v_lshlrev_b32 v12, 5, v6
    v_add_u32 v12, s3, v12
    v_and_b32 v13, 1, v4
    v_lshl_add_u32 v13, v13, 4, v12
    v_add_u32 v13, 64, v13
    v_lshl_add_u32 v12, v4, 4, v12
    s_mul_i32 s3, s50, 524288
    s_add_u32 s3, s3, 0
    s_lshl_b32 s75, s49, 11
    s_add_u32 s3, s3, s75
    s_lshl_b32 s75, s18, 8
    s_add_u32 s3, s3, s75
    v_lshlrev_b32 v14, 16, v4
    v_lshl_add_u32 v14, v6, 4, v14
    v_add_u32 v14, s3, v14
    v_mov_b32 v38, 163824
    v_mov_b32 v45, 1
    s_mov_b32 exec_hi, 0xffff
    ds_write_b128 v29, v[48:51]
    s_mov_b64 exec, -1
    ds_write_b16 v31, v34 offset:16
    ds_write_b16 v31, v34 offset:110
    ds_write_b16_d16_hi v31, v34 offset:208
    ds_write_b16_d16_hi v31, v34 offset:302
    ds_read2_b32 v[128:129], v42 offset0:0 offset1:1
    ds_read2_b32 v[130:131], v42 offset0:2 offset1:3
    ds_read2_b32 v[132:133], v43 offset0:0 offset1:1
    ds_read2_b32 v[134:135], v43 offset0:2 offset1:3
    s_waitcnt lgkmcnt(10)
    ds_read2_b32 v[136:137], v42 offset0:48 offset1:49
    ds_read2_b32 v[138:139], v42 offset0:50 offset1:51
    ds_read2_b32 v[140:141], v43 offset0:48 offset1:49
    ds_read2_b32 v[142:143], v43 offset0:50 offset1:51
    s_waitcnt lgkmcnt(10)
    ds_read2_b32 v[160:161], v42 offset0:96 offset1:97
    ds_read2_b32 v[162:163], v42 offset0:98 offset1:99
    ds_read2_b32 v[164:165], v43 offset0:96 offset1:97
    ds_read2_b32 v[166:167], v43 offset0:98 offset1:99
    s_waitcnt lgkmcnt(10)
    ds_read2_b32 v[168:169], v42 offset0:144 offset1:145
    ds_read2_b32 v[170:171], v42 offset0:146 offset1:147
    ds_read2_b32 v[172:173], v43 offset0:144 offset1:145
    ds_read2_b32 v[174:175], v43 offset0:146 offset1:147
    s_waitcnt lgkmcnt(10)
    s_waitcnt vmcnt(2)
    s_barrier
    s_add_u32 m0, s74, 106496
    s_add_u32 s75, s19, 6
    s_and_b32 s75, s75, 7
    s_lshl_b32 s75, s75, 16
    s_add_u32 s75, s75, 0
    buffer_load_dwordx4 v47, s[28:31], s75 offen lds
    s_add_u32 m0, s74, 110592
    s_add_u32 s75, s19, 6
    s_and_b32 s75, s75, 7
    s_lshl_b32 s75, s75, 16
    s_add_u32 s75, s75, 16384
    buffer_load_dwordx4 v47, s[28:31], s75 offen lds
    s_add_u32 m0, s74, 114688
    s_add_u32 s75, s19, 7
    s_and_b32 s75, s75, 7
    s_lshl_b32 s75, s75, 16
    s_add_u32 s75, s75, 0
    buffer_load_dwordx4 v47, s[28:31], s75 offen lds
    s_add_u32 m0, s74, 118784
    s_add_u32 s75, s19, 7
    s_and_b32 s75, s75, 7
    s_lshl_b32 s75, s75, 16
    s_add_u32 s75, s75, 16384
    buffer_load_dwordx4 v47, s[28:31], s75 offen lds
    s_add_u32 m0, s74, 0
    s_add_u32 s75, s19, 0
    s_and_b32 s75, s75, 7
    s_lshl_b32 s75, s75, 16
    s_add_u32 s75, s75, 0
    buffer_load_dwordx4 v47, s[28:31], s75 offen lds
    s_add_u32 m0, s74, 4096
    s_add_u32 s75, s19, 0
    s_and_b32 s75, s75, 7
    s_lshl_b32 s75, s75, 16
    s_add_u32 s75, s75, 16384
    buffer_load_dwordx4 v47, s[28:31], s75 offen lds
    s_add_u32 m0, s74, 8192
    s_add_u32 s75, s19, 1
    s_and_b32 s75, s75, 7
    s_lshl_b32 s75, s75, 16
    s_add_u32 s75, s75, 0
    buffer_load_dwordx4 v47, s[28:31], s75 offen lds
    s_add_u32 m0, s74, 12288
    s_add_u32 s75, s19, 1
    s_and_b32 s75, s75, 7
    s_lshl_b32 s75, s75, 16
    s_add_u32 s75, s75, 16384
    buffer_load_dwordx4 v47, s[28:31], s75 offen lds
    s_add_u32 m0, s74, 16384
    s_add_u32 s75, s19, 2
    s_and_b32 s75, s75, 7
    s_lshl_b32 s75, s75, 16
    s_add_u32 s75, s75, 0
    buffer_load_dwordx4 v47, s[28:31], s75 offen lds
    s_add_u32 m0, s74, 20480
    s_add_u32 s75, s19, 2
    s_and_b32 s75, s75, 7
    s_lshl_b32 s75, s75, 16
    s_add_u32 s75, s75, 16384
    buffer_load_dwordx4 v47, s[28:31], s75 offen lds
    s_add_u32 m0, s74, 24576
    s_add_u32 s75, s19, 3
    s_and_b32 s75, s75, 7
    s_lshl_b32 s75, s75, 16
    s_add_u32 s75, s75, 0
    buffer_load_dwordx4 v47, s[28:31], s75 offen lds
    s_add_u32 m0, s74, 28672
    s_add_u32 s75, s19, 3
    s_and_b32 s75, s75, 7
    s_lshl_b32 s75, s75, 16
    s_add_u32 s75, s75, 16384
    buffer_load_dwordx4 v47, s[28:31], s75 offen lds
    s_add_u32 m0, s74, 32768
    s_add_u32 s75, s19, 4
    s_and_b32 s75, s75, 7
    s_lshl_b32 s75, s75, 16
    s_add_u32 s75, s75, 0
    buffer_load_dwordx4 v47, s[28:31], s75 offen lds
    s_add_u32 m0, s74, 36864
    s_add_u32 s75, s19, 4
    s_and_b32 s75, s75, 7
    s_lshl_b32 s75, s75, 16
    s_add_u32 s75, s75, 16384
    buffer_load_dwordx4 v47, s[28:31], s75 offen lds
    s_add_u32 m0, s74, 40960
    s_add_u32 s75, s19, 5
    s_and_b32 s75, s75, 7
    s_lshl_b32 s75, s75, 16
    s_add_u32 s75, s75, 0
    buffer_load_dwordx4 v47, s[28:31], s75 offen lds
    s_add_u32 m0, s74, 45056
    s_add_u32 s75, s19, 5
    s_and_b32 s75, s75, 7
    s_lshl_b32 s75, s75, 16
    s_add_u32 s75, s75, 16384
    buffer_load_dwordx4 v47, s[28:31], s75 offen lds
    ds_write_b16 v31, v35 offset:16
    ds_write_b16 v31, v35 offset:110
    ds_write_b16_d16_hi v31, v35 offset:208
    ds_write_b16_d16_hi v31, v35 offset:302
    ds_read2_b32 v[144:145], v42 offset0:0 offset1:1
    ds_read2_b32 v[146:147], v42 offset0:2 offset1:3
    ds_read2_b32 v[148:149], v43 offset0:0 offset1:1
    ds_read2_b32 v[150:151], v43 offset0:2 offset1:3
    s_waitcnt lgkmcnt(10)
    ds_read2_b32 v[152:153], v42 offset0:48 offset1:49
    ds_read2_b32 v[154:155], v42 offset0:50 offset1:51
    ds_read2_b32 v[156:157], v43 offset0:48 offset1:49
    ds_read2_b32 v[158:159], v43 offset0:50 offset1:51
    s_waitcnt lgkmcnt(10)
    ds_read2_b32 v[176:177], v42 offset0:96 offset1:97
    ds_read2_b32 v[178:179], v42 offset0:98 offset1:99
    ds_read2_b32 v[180:181], v43 offset0:96 offset1:97
    ds_read2_b32 v[182:183], v43 offset0:98 offset1:99
    s_waitcnt lgkmcnt(10)
    ds_read2_b32 v[184:185], v42 offset0:144 offset1:145
    ds_read2_b32 v[186:187], v42 offset0:146 offset1:147
    ds_read2_b32 v[188:189], v43 offset0:144 offset1:145
    ds_read2_b32 v[190:191], v43 offset0:146 offset1:147
    s_waitcnt lgkmcnt(10)
    ds_write_b16 v31, v36 offset:16
    ds_write_b16 v31, v36 offset:110
    ds_write_b16_d16_hi v31, v36 offset:208
    ds_write_b16_d16_hi v31, v36 offset:302
    ds_read2_b32 v[192:193], v42 offset0:0 offset1:1
    ds_read2_b32 v[194:195], v42 offset0:2 offset1:3
    ds_read2_b32 v[196:197], v43 offset0:0 offset1:1
    ds_read2_b32 v[198:199], v43 offset0:2 offset1:3
    s_waitcnt lgkmcnt(10)
    ds_read2_b32 v[200:201], v42 offset0:48 offset1:49
    ds_read2_b32 v[202:203], v42 offset0:50 offset1:51
    ds_read2_b32 v[204:205], v43 offset0:48 offset1:49
    ds_read2_b32 v[206:207], v43 offset0:50 offset1:51
    s_waitcnt lgkmcnt(10)
    ds_read2_b32 v[224:225], v42 offset0:96 offset1:97
    ds_read2_b32 v[226:227], v42 offset0:98 offset1:99
    ds_read2_b32 v[228:229], v43 offset0:96 offset1:97
    ds_read2_b32 v[230:231], v43 offset0:98 offset1:99
    s_waitcnt lgkmcnt(10)
    ds_read2_b32 v[232:233], v42 offset0:144 offset1:145
    ds_read2_b32 v[234:235], v42 offset0:146 offset1:147
    ds_read2_b32 v[236:237], v43 offset0:144 offset1:145
    ds_read2_b32 v[238:239], v43 offset0:146 offset1:147
    s_waitcnt lgkmcnt(10)
    v_add_u32 v16, 1, v120
    v_add_u32 v17, 1, v121
    v_mov_b32 v18, 2
    v_lshrrev_b32 v7, 1, v5
    v_mul_u32_u24 v7, 592, v7
    v_and_b32 v8, 1, v5
    v_lshl_add_u32 v7, v8, 3, v7
    s_mov_b64 exec, 0xff
    v_add_u32 v7, 161456, v7
    ds_write_b64 v7, v[120:121]
    s_mov_b64 exec, -1
    s_waitcnt lgkmcnt(0)
    s_setprio 2
    s_barrier
    ds_read_b128 v[48:51], v12 offset:0
    ds_read_b128 v[52:55], v13 offset:0
    ds_read_b128 v[56:59], v12 offset:592
    ds_read_b128 v[60:63], v13 offset:592
    ds_read_b128 v[64:67], v12 offset:1184
    ds_read_b128 v[68:71], v13 offset:1184
    ds_read_b128 v[72:75], v12 offset:1776
    ds_read_b128 v[76:79], v13 offset:1776
    s_waitcnt lgkmcnt(6)
    v_mfma_f32_16x16x32_bf16 v[80:83], v[48:51], v[128:131], 0
    v_mfma_f32_16x16x32_bf16 v[80:83], v[52:55], v[132:135], v[80:83]
    ds_read_b128 v[48:51], v12 offset:2368
    ds_read_b128 v[52:55], v13 offset:2368
    s_waitcnt lgkmcnt(6)
    v_mfma_f32_16x16x32_bf16 v[84:87], v[56:59], v[136:139], 0
    v_mfma_f32_16x16x32_bf16 v[84:87], v[60:63], v[140:143], v[84:87]
    ds_read_b128 v[56:59], v12 offset:2960
    ds_read_b128 v[60:63], v13 offset:2960
    s_waitcnt lgkmcnt(6)
    v_mfma_f32_16x16x32_bf16 v[88:91], v[64:67], v[144:147], 0
    v_mfma_f32_16x16x32_bf16 v[88:91], v[68:71], v[148:151], v[88:91]
    ds_read_b128 v[64:67], v12 offset:3552
    ds_read_b128 v[68:71], v13 offset:3552
    s_waitcnt lgkmcnt(6)
    v_mfma_f32_16x16x32_bf16 v[92:95], v[72:75], v[152:155], 0
    v_mfma_f32_16x16x32_bf16 v[92:95], v[76:79], v[156:159], v[92:95]
    ds_read_b128 v[72:75], v12 offset:4144
    ds_read_b128 v[76:79], v13 offset:4144
    s_waitcnt lgkmcnt(6)
    v_mfma_f32_16x16x32_bf16 v[96:99], v[48:51], v[160:163], 0
    v_mfma_f32_16x16x32_bf16 v[96:99], v[52:55], v[164:167], v[96:99]
    s_waitcnt lgkmcnt(4)
    v_mfma_f32_16x16x32_bf16 v[100:103], v[56:59], v[168:171], 0
    v_mfma_f32_16x16x32_bf16 v[100:103], v[60:63], v[172:175], v[100:103]
    s_waitcnt lgkmcnt(2)
    v_mfma_f32_16x16x32_bf16 v[104:107], v[64:67], v[176:179], 0
    v_mfma_f32_16x16x32_bf16 v[104:107], v[68:71], v[180:183], v[104:107]
    s_waitcnt lgkmcnt(0)
    v_mfma_f32_16x16x32_bf16 v[108:111], v[72:75], v[184:187], 0
    v_mfma_f32_16x16x32_bf16 v[108:111], v[76:79], v[188:191], v[108:111]
    v_pk_mul_f32 v[112:113], v[80:81], s[76:77]
    v_pk_mul_f32 v[114:115], v[84:85], s[76:77]
    v_exp_f32 v112, v112
    v_exp_f32 v113, v113
    v_exp_f32 v114, v114
    v_exp_f32 v115, v115
    v_pk_add_f32 v[112:113], v[112:113], 1.0 op_sel_hi:[1,0]
    v_pk_add_f32 v[114:115], v[114:115], 1.0 op_sel_hi:[1,0]
    v_rcp_f32 v112, v112
    v_rcp_f32 v113, v113
    v_rcp_f32 v114, v114
    v_rcp_f32 v115, v115
    v_pk_mul_f32 v[80:81], v[112:113], v[80:81]
    v_pk_mul_f32 v[84:85], v[114:115], v[84:85]
    v_pk_mul_f32 v[116:117], v[88:89], s[76:77]
    v_pk_mul_f32 v[118:119], v[92:93], s[76:77]
    v_exp_f32 v116, v116
    v_exp_f32 v117, v117
    v_exp_f32 v118, v118
    v_exp_f32 v119, v119
    v_pk_add_f32 v[116:117], v[116:117], 1.0 op_sel_hi:[1,0]
    v_pk_add_f32 v[118:119], v[118:119], 1.0 op_sel_hi:[1,0]
    v_rcp_f32 v116, v116
    v_rcp_f32 v117, v117
    v_rcp_f32 v118, v118
    v_rcp_f32 v119, v119
    v_pk_mul_f32 v[88:89], v[116:117], v[88:89]
    v_pk_mul_f32 v[92:93], v[118:119], v[92:93]
    v_pk_mul_f32 v[112:113], v[96:97], s[76:77]
    v_pk_mul_f32 v[114:115], v[100:101], s[76:77]
    v_exp_f32 v112, v112
    v_exp_f32 v113, v113
    v_exp_f32 v114, v114
    v_exp_f32 v115, v115
    v_pk_add_f32 v[112:113], v[112:113], 1.0 op_sel_hi:[1,0]
    v_pk_add_f32 v[114:115], v[114:115], 1.0 op_sel_hi:[1,0]
    v_rcp_f32 v112, v112
    v_rcp_f32 v113, v113
    v_rcp_f32 v114, v114
    v_rcp_f32 v115, v115
    v_pk_mul_f32 v[96:97], v[112:113], v[96:97]
    v_pk_mul_f32 v[100:101], v[114:115], v[100:101]
    v_pk_mul_f32 v[116:117], v[104:105], s[76:77]
    v_pk_mul_f32 v[118:119], v[108:109], s[76:77]
    v_exp_f32 v116, v116
    v_exp_f32 v117, v117
    v_exp_f32 v118, v118
    v_exp_f32 v119, v119
    v_pk_add_f32 v[116:117], v[116:117], 1.0 op_sel_hi:[1,0]
    v_pk_add_f32 v[118:119], v[118:119], 1.0 op_sel_hi:[1,0]
    v_rcp_f32 v116, v116
    v_rcp_f32 v117, v117
    v_rcp_f32 v118, v118
    v_rcp_f32 v119, v119
    v_pk_mul_f32 v[104:105], v[116:117], v[104:105]
    v_pk_mul_f32 v[108:109], v[118:119], v[108:109]
    v_cvt_pk_bf16_f32 v64, v80, v84
    v_cvt_pk_bf16_f32 v65, v88, v92
    v_cvt_pk_bf16_f32 v66, v96, v100
    v_cvt_pk_bf16_f32 v67, v104, v108
    s_mov_b32 s3, 0
    buffer_store_dwordx4 v[64:67], v14, s[40:43], s3 offen offset:0 sc1
    v_cvt_pk_bf16_f32 v68, v81, v85
    v_cvt_pk_bf16_f32 v69, v89, v93
    v_cvt_pk_bf16_f32 v70, v97, v101
    v_cvt_pk_bf16_f32 v71, v105, v109
    s_mov_b32 s3, 16384
    buffer_store_dwordx4 v[68:71], v14, s[40:43], s3 offen offset:0 sc1
    v_pk_mul_f32 v[112:113], v[82:83], s[76:77]
    v_pk_mul_f32 v[114:115], v[86:87], s[76:77]
    v_exp_f32 v112, v112
    v_exp_f32 v113, v113
    v_exp_f32 v114, v114
    v_exp_f32 v115, v115
    v_pk_add_f32 v[112:113], v[112:113], 1.0 op_sel_hi:[1,0]
    v_pk_add_f32 v[114:115], v[114:115], 1.0 op_sel_hi:[1,0]
    v_rcp_f32 v112, v112
    v_rcp_f32 v113, v113
    v_rcp_f32 v114, v114
    v_rcp_f32 v115, v115
    v_pk_mul_f32 v[82:83], v[112:113], v[82:83]
    v_pk_mul_f32 v[86:87], v[114:115], v[86:87]
    v_pk_mul_f32 v[116:117], v[90:91], s[76:77]
    v_pk_mul_f32 v[118:119], v[94:95], s[76:77]
    v_exp_f32 v116, v116
    v_exp_f32 v117, v117
    v_exp_f32 v118, v118
    v_exp_f32 v119, v119
    v_pk_add_f32 v[116:117], v[116:117], 1.0 op_sel_hi:[1,0]
    v_pk_add_f32 v[118:119], v[118:119], 1.0 op_sel_hi:[1,0]
    v_rcp_f32 v116, v116
    v_rcp_f32 v117, v117
    v_rcp_f32 v118, v118
    v_rcp_f32 v119, v119
    v_pk_mul_f32 v[90:91], v[116:117], v[90:91]
    v_pk_mul_f32 v[94:95], v[118:119], v[94:95]
    v_pk_mul_f32 v[112:113], v[98:99], s[76:77]
    v_pk_mul_f32 v[114:115], v[102:103], s[76:77]
    v_exp_f32 v112, v112
    v_exp_f32 v113, v113
    v_exp_f32 v114, v114
    v_exp_f32 v115, v115
    v_pk_add_f32 v[112:113], v[112:113], 1.0 op_sel_hi:[1,0]
    v_pk_add_f32 v[114:115], v[114:115], 1.0 op_sel_hi:[1,0]
    v_rcp_f32 v112, v112
    v_rcp_f32 v113, v113
    v_rcp_f32 v114, v114
    v_rcp_f32 v115, v115
    v_pk_mul_f32 v[98:99], v[112:113], v[98:99]
    v_pk_mul_f32 v[102:103], v[114:115], v[102:103]
    v_pk_mul_f32 v[116:117], v[106:107], s[76:77]
    v_pk_mul_f32 v[118:119], v[110:111], s[76:77]
    v_exp_f32 v116, v116
    v_exp_f32 v117, v117
    v_exp_f32 v118, v118
    v_exp_f32 v119, v119
    v_pk_add_f32 v[116:117], v[116:117], 1.0 op_sel_hi:[1,0]
    v_pk_add_f32 v[118:119], v[118:119], 1.0 op_sel_hi:[1,0]
    v_rcp_f32 v116, v116
    v_rcp_f32 v117, v117
    v_rcp_f32 v118, v118
    v_rcp_f32 v119, v119
    v_pk_mul_f32 v[106:107], v[116:117], v[106:107]
    v_pk_mul_f32 v[110:111], v[118:119], v[110:111]
    v_cvt_pk_bf16_f32 v72, v82, v86
    v_cvt_pk_bf16_f32 v73, v90, v94
    v_cvt_pk_bf16_f32 v74, v98, v102
    v_cvt_pk_bf16_f32 v75, v106, v110
    s_mov_b32 s3, 32768
    buffer_store_dwordx4 v[72:75], v14, s[40:43], s3 offen offset:0 sc1
    v_cvt_pk_bf16_f32 v76, v83, v87
    v_cvt_pk_bf16_f32 v77, v91, v95
    v_cvt_pk_bf16_f32 v78, v99, v103
    v_cvt_pk_bf16_f32 v79, v107, v111
    s_mov_b32 s3, 49152
    buffer_store_dwordx4 v[76:79], v14, s[40:43], s3 offen offset:0 sc1
    ds_write_b16 v31, v37 offset:16
    ds_write_b16 v31, v37 offset:110
    ds_write_b16_d16_hi v31, v37 offset:208
    ds_write_b16_d16_hi v31, v37 offset:302
    ds_read2_b32 v[208:209], v42 offset0:0 offset1:1
    ds_read2_b32 v[210:211], v42 offset0:2 offset1:3
    ds_read2_b32 v[212:213], v43 offset0:0 offset1:1
    ds_read2_b32 v[214:215], v43 offset0:2 offset1:3
    s_waitcnt lgkmcnt(10)
    ds_read2_b32 v[216:217], v42 offset0:48 offset1:49
    ds_read2_b32 v[218:219], v42 offset0:50 offset1:51
    ds_read2_b32 v[220:221], v43 offset0:48 offset1:49
    ds_read2_b32 v[222:223], v43 offset0:50 offset1:51
    s_waitcnt lgkmcnt(10)
    ds_read2_b32 v[240:241], v42 offset0:96 offset1:97
    ds_read2_b32 v[242:243], v42 offset0:98 offset1:99
    ds_read2_b32 v[244:245], v43 offset0:96 offset1:97
    ds_read2_b32 v[246:247], v43 offset0:98 offset1:99
    s_waitcnt lgkmcnt(10)
    ds_read2_b32 v[248:249], v42 offset0:144 offset1:145
    ds_read2_b32 v[250:251], v42 offset0:146 offset1:147
    ds_read2_b32 v[252:253], v43 offset0:144 offset1:145
    ds_read2_b32 v[254:255], v43 offset0:146 offset1:147
    s_waitcnt lgkmcnt(10)
    s_mov_b64 exec, 1
    s_waitcnt vmcnt(0)
    ds_add_rtn_u32 v46, v38, v45 offset:0
    s_waitcnt lgkmcnt(0)
    v_cmp_eq_u32 vcc, 3, v46
    s_nop 4
    s_cbranch_vccz L_noflag0
    s_mov_b64 exec, s[80:81]
    buffer_store_dword v16, v39, s[40:43], 0 offen offset:0
L_noflag0:
    s_mov_b64 exec, -1
    s_waitcnt lgkmcnt(0)
    s_barrier
    ds_read_b128 v[48:51], v12 offset:18944
    ds_read_b128 v[52:55], v13 offset:18944
    ds_read_b128 v[56:59], v12 offset:19536
    ds_read_b128 v[60:63], v13 offset:19536
    ds_read_b128 v[64:67], v12 offset:20128
    ds_read_b128 v[68:71], v13 offset:20128
    ds_read_b128 v[72:75], v12 offset:20720
    ds_read_b128 v[76:79], v13 offset:20720
    s_waitcnt lgkmcnt(6)
    v_mfma_f32_16x16x32_bf16 v[80:83], v[48:51], v[192:195], 0
    v_mfma_f32_16x16x32_bf16 v[80:83], v[52:55], v[196:199], v[80:83]
    ds_read_b128 v[48:51], v12 offset:21312
    ds_read_b128 v[52:55], v13 offset:21312
    s_waitcnt lgkmcnt(6)
    v_mfma_f32_16x16x32_bf16 v[84:87], v[56:59], v[200:203], 0
    v_mfma_f32_16x16x32_bf16 v[84:87], v[60:63], v[204:207], v[84:87]
    ds_read_b128 v[56:59], v12 offset:21904
    ds_read_b128 v[60:63], v13 offset:21904
    s_waitcnt lgkmcnt(6)
    v_mfma_f32_16x16x32_bf16 v[88:91], v[64:67], v[208:211], 0
    v_mfma_f32_16x16x32_bf16 v[88:91], v[68:71], v[212:215], v[88:91]
    ds_read_b128 v[64:67], v12 offset:22496
    ds_read_b128 v[68:71], v13 offset:22496
    s_waitcnt lgkmcnt(6)
    v_mfma_f32_16x16x32_bf16 v[92:95], v[72:75], v[216:219], 0
    v_mfma_f32_16x16x32_bf16 v[92:95], v[76:79], v[220:223], v[92:95]
    ds_read_b128 v[72:75], v12 offset:23088
    ds_read_b128 v[76:79], v13 offset:23088
    s_waitcnt lgkmcnt(6)
    v_mfma_f32_16x16x32_bf16 v[96:99], v[48:51], v[224:227], 0
    v_mfma_f32_16x16x32_bf16 v[96:99], v[52:55], v[228:231], v[96:99]
    s_waitcnt lgkmcnt(4)
    v_mfma_f32_16x16x32_bf16 v[100:103], v[56:59], v[232:235], 0
    v_mfma_f32_16x16x32_bf16 v[100:103], v[60:63], v[236:239], v[100:103]
    s_waitcnt lgkmcnt(2)
    v_mfma_f32_16x16x32_bf16 v[104:107], v[64:67], v[240:243], 0
    v_mfma_f32_16x16x32_bf16 v[104:107], v[68:71], v[244:247], v[104:107]
    s_waitcnt lgkmcnt(0)
    v_mfma_f32_16x16x32_bf16 v[108:111], v[72:75], v[248:251], 0
    v_mfma_f32_16x16x32_bf16 v[108:111], v[76:79], v[252:255], v[108:111]
    v_pk_mul_f32 v[112:113], v[80:81], s[76:77]
    v_pk_mul_f32 v[114:115], v[84:85], s[76:77]
    v_exp_f32 v112, v112
    v_exp_f32 v113, v113
    v_exp_f32 v114, v114
    v_exp_f32 v115, v115
    v_pk_add_f32 v[112:113], v[112:113], 1.0 op_sel_hi:[1,0]
    v_pk_add_f32 v[114:115], v[114:115], 1.0 op_sel_hi:[1,0]
    v_rcp_f32 v112, v112
    v_rcp_f32 v113, v113
    v_rcp_f32 v114, v114
    v_rcp_f32 v115, v115
    v_pk_mul_f32 v[80:81], v[112:113], v[80:81]
    v_pk_mul_f32 v[84:85], v[114:115], v[84:85]
    v_pk_mul_f32 v[116:117], v[88:89], s[76:77]
    v_pk_mul_f32 v[118:119], v[92:93], s[76:77]
    v_exp_f32 v116, v116
    v_exp_f32 v117, v117
    v_exp_f32 v118, v118
    v_exp_f32 v119, v119
    v_pk_add_f32 v[116:117], v[116:117], 1.0 op_sel_hi:[1,0]
    v_pk_add_f32 v[118:119], v[118:119], 1.0 op_sel_hi:[1,0]
    v_rcp_f32 v116, v116
    v_rcp_f32 v117, v117
    v_rcp_f32 v118, v118
    v_rcp_f32 v119, v119
    v_pk_mul_f32 v[88:89], v[116:117], v[88:89]
    v_pk_mul_f32 v[92:93], v[118:119], v[92:93]
    v_pk_mul_f32 v[112:113], v[96:97], s[76:77]
    v_pk_mul_f32 v[114:115], v[100:101], s[76:77]
    v_exp_f32 v112, v112
    v_exp_f32 v113, v113
    v_exp_f32 v114, v114
    v_exp_f32 v115, v115
    v_pk_add_f32 v[112:113], v[112:113], 1.0 op_sel_hi:[1,0]
    v_pk_add_f32 v[114:115], v[114:115], 1.0 op_sel_hi:[1,0]
    v_rcp_f32 v112, v112
    v_rcp_f32 v113, v113
    v_rcp_f32 v114, v114
    v_rcp_f32 v115, v115
    v_pk_mul_f32 v[96:97], v[112:113], v[96:97]
    v_pk_mul_f32 v[100:101], v[114:115], v[100:101]
    v_pk_mul_f32 v[116:117], v[104:105], s[76:77]
    v_pk_mul_f32 v[118:119], v[108:109], s[76:77]
    v_exp_f32 v116, v116
    v_exp_f32 v117, v117
    v_exp_f32 v118, v118
    v_exp_f32 v119, v119
    v_pk_add_f32 v[116:117], v[116:117], 1.0 op_sel_hi:[1,0]
    v_pk_add_f32 v[118:119], v[118:119], 1.0 op_sel_hi:[1,0]
    v_rcp_f32 v116, v116
    v_rcp_f32 v117, v117
    v_rcp_f32 v118, v118
    v_rcp_f32 v119, v119
    v_pk_mul_f32 v[104:105], v[116:117], v[104:105]
    v_pk_mul_f32 v[108:109], v[118:119], v[108:109]
    v_cvt_pk_bf16_f32 v48, v80, v84
    v_cvt_pk_bf16_f32 v49, v88, v92
    v_cvt_pk_bf16_f32 v50, v96, v100
    v_cvt_pk_bf16_f32 v51, v104, v108
    s_mov_b32 s3, 0
    buffer_store_dwordx4 v[48:51], v14, s[40:43], s3 offen offset:1024 sc1
    v_cvt_pk_bf16_f32 v52, v81, v85
    v_cvt_pk_bf16_f32 v53, v89, v93
    v_cvt_pk_bf16_f32 v54, v97, v101
    v_cvt_pk_bf16_f32 v55, v105, v109
    s_mov_b32 s3, 16384
    buffer_store_dwordx4 v[52:55], v14, s[40:43], s3 offen offset:1024 sc1
    v_pk_mul_f32 v[112:113], v[82:83], s[76:77]
    v_pk_mul_f32 v[114:115], v[86:87], s[76:77]
    v_exp_f32 v112, v112
    v_exp_f32 v113, v113
    v_exp_f32 v114, v114
    v_exp_f32 v115, v115
    v_pk_add_f32 v[112:113], v[112:113], 1.0 op_sel_hi:[1,0]
    v_pk_add_f32 v[114:115], v[114:115], 1.0 op_sel_hi:[1,0]
    v_rcp_f32 v112, v112
    v_rcp_f32 v113, v113
    v_rcp_f32 v114, v114
    v_rcp_f32 v115, v115
    v_pk_mul_f32 v[82:83], v[112:113], v[82:83]
    v_pk_mul_f32 v[86:87], v[114:115], v[86:87]
    v_pk_mul_f32 v[116:117], v[90:91], s[76:77]
    v_pk_mul_f32 v[118:119], v[94:95], s[76:77]
    v_exp_f32 v116, v116
    v_exp_f32 v117, v117
    v_exp_f32 v118, v118
    v_exp_f32 v119, v119
    v_pk_add_f32 v[116:117], v[116:117], 1.0 op_sel_hi:[1,0]
    v_pk_add_f32 v[118:119], v[118:119], 1.0 op_sel_hi:[1,0]
    v_rcp_f32 v116, v116
    v_rcp_f32 v117, v117
    v_rcp_f32 v118, v118
    v_rcp_f32 v119, v119
    v_pk_mul_f32 v[90:91], v[116:117], v[90:91]
    v_pk_mul_f32 v[94:95], v[118:119], v[94:95]
    v_pk_mul_f32 v[112:113], v[98:99], s[76:77]
    v_pk_mul_f32 v[114:115], v[102:103], s[76:77]
    v_exp_f32 v112, v112
    v_exp_f32 v113, v113
    v_exp_f32 v114, v114
    v_exp_f32 v115, v115
    v_pk_add_f32 v[112:113], v[112:113], 1.0 op_sel_hi:[1,0]
    v_pk_add_f32 v[114:115], v[114:115], 1.0 op_sel_hi:[1,0]
    v_rcp_f32 v112, v112
    v_rcp_f32 v113, v113
    v_rcp_f32 v114, v114
    v_rcp_f32 v115, v115
    v_pk_mul_f32 v[98:99], v[112:113], v[98:99]
    v_pk_mul_f32 v[102:103], v[114:115], v[102:103]
    v_pk_mul_f32 v[116:117], v[106:107], s[76:77]
    v_pk_mul_f32 v[118:119], v[110:111], s[76:77]
    v_exp_f32 v116, v116
    v_exp_f32 v117, v117
    v_exp_f32 v118, v118
    v_exp_f32 v119, v119
    v_pk_add_f32 v[116:117], v[116:117], 1.0 op_sel_hi:[1,0]
    v_pk_add_f32 v[118:119], v[118:119], 1.0 op_sel_hi:[1,0]
    v_rcp_f32 v116, v116
    v_rcp_f32 v117, v117
    v_rcp_f32 v118, v118
    v_rcp_f32 v119, v119
    v_pk_mul_f32 v[106:107], v[116:117], v[106:107]
    v_pk_mul_f32 v[110:111], v[118:119], v[110:111]
    v_cvt_pk_bf16_f32 v56, v82, v86
    v_cvt_pk_bf16_f32 v57, v90, v94
    v_cvt_pk_bf16_f32 v58, v98, v102
    v_cvt_pk_bf16_f32 v59, v106, v110
    s_mov_b32 s3, 32768
    buffer_store_dwordx4 v[56:59], v14, s[40:43], s3 offen offset:1024 sc1
    v_cvt_pk_bf16_f32 v60, v83, v87
    v_cvt_pk_bf16_f32 v61, v91, v95
    v_cvt_pk_bf16_f32 v62, v99, v103
    v_cvt_pk_bf16_f32 v63, v107, v111
    s_mov_b32 s3, 49152
    buffer_store_dwordx4 v[60:63], v14, s[40:43], s3 offen offset:1024 sc1
    s_lshl_b32 s3, s18, 2
    s_add_u32 s3, s3, 160864
    v_mov_b32 v46, s3
    ds_write_b32 v46, v45
    s_mov_b64 exec, 0xff
    buffer_load_dword v125, v39, s[40:43], 0 offen offset:8 sc1
    s_mov_b64 exec, 1
    s_waitcnt vmcnt(0)
    ds_add_rtn_u32 v46, v38, v45 offset:4
    s_waitcnt lgkmcnt(0)
    v_cmp_eq_u32 vcc, 3, v46
    s_nop 4
    s_cbranch_vccz L_noflag1
    s_mov_b64 exec, s[80:81]
    buffer_store_dword v17, v39, s[40:43], 0 offen offset:4
    s_mov_b64 exec, 0xff
    v_cmp_ne_u32 vcc, v124, v125
    s_nop 4
    s_cbranch_vccz L_noflag1
    s_mov_b64 exec, s[80:81]
    buffer_store_byte v18, v33, s[44:47], 0 offen sc1
L_noflag1:
    s_mov_b64 exec, -1
    s_cmp_lg_u32 s18, 0
    s_cbranch_scc1 L_lnopoll
    s_mov_b64 exec, 0xff
    s_mov_b32 s3, 0
L_pollB:
    buffer_load_dword v64, v39, s[40:43], 0 offen offset:4 sc1
    s_add_u32 s3, s3, 1
    s_waitcnt vmcnt(0)
    v_cmp_eq_u32 vcc, v121, v64
    s_nop 4
    s_cbranch_vccz L_pollB_done
    s_cmp_lt_u32 s3, 24
    s_cbranch_scc1 L_pollB
    buffer_load_ubyte v66, v33, s[44:47], 0 offen sc1
    s_waitcnt vmcnt(0)
    v_cmp_ne_u32 s[72:73], 2, v66
    s_nop 4
    s_and_b64 s[72:73], s[72:73], vcc
    s_cbranch_scc0 L_pollB_done
    s_sleep 8
    s_cmp_lt_u32 s3, 0x80000
    s_cbranch_scc1 L_pollB
L_pollB_done:
    s_mov_b64 exec, -1
L_lnopoll:
    s_barrier
    s_branch L_fin
L_compute:
    s_waitcnt lgkmcnt(0)
    s_add_u32 s20, s4, s57
    s_addc_u32 s21, s5, 0
    s_mov_b32 s24, s6
    s_mov_b32 s25, s7

    s_mov_b32 s28, s10
    s_mov_b32 s29, s11
    s_mov_b32 s30, 524288
    s_mov_b32 s31, 0x20000
    s_mov_b32 s32, s8
    s_mov_b32 s33, s9
    s_mov_b32 s34, 31744
    s_mov_b32 s35, 0x20000
    s_lshl_b32 s59, s56, 10
    s_add_u32 s59, s59, s57
    s_add_u32 s36, s12, s59
    s_addc_u32 s37, s13, 0
    s_mov_b32 s38, 256000
    s_mov_b32 s39, 0x20000
    s_mov_b32 s40, s16
    s_mov_b32 s41, s17
    s_mov_b32 s42, 0x8000000
    s_mov_b32 s43, 0x20000
    s_mov_b32 s44, s14
    s_mov_b32 s45, s15
    s_mov_b32 s46, 256
    s_mov_b32 s47, 0x20000
    s_mov_b32 s76, 0xbfb8aa3b
    s_mov_b32 s77, 0xbfb8aa3b
    s_and_b32 s19, s49, 6

    v_mov_b32 v252, 0
    v_mov_b32 v253, 0
    v_mov_b32 v254, 0
    v_mov_b32 v255, 0
    v_mov_b32 v15, 163824
    ds_write_b128 v15, v[252:255]
    v_mov_b32 v1, 160864
    ds_write_b128 v1, v[252:255]
    s_lshl_b32 s3, s18, 2
    v_add_u32 v1, s3, v1
    s_cmp_lg_u32 s48, 1
    s_cbranch_scc1 L_nopf
    s_getpc_b64 s[78:79]
L_pc:
    s_sub_u32 s78, s78, L_pc-L_start
    s_subb_u32 s79, s79, 0
    s_lshr_b32 s3, s2, 3
    s_lshl_b32 s3, s3, 10
    v_lshlrev_b32 v251, 7, v2
    v_add_u32 v251, s3, v251
    v_min_u32 v251, L_end-L_start, v251
    s_mov_b64 exec, 0xff
    global_load_dword v252, v251, s[78:79]
    s_mov_b64 exec, -1
L_nopf:
    s_cmp_lg_u32 s48, 2
    s_cbranch_scc1 L_nodwpf
    s_lshr_b32 s3, s2, 3
    s_lshl_b32 s3, s3, 10
    v_lshlrev_b32 v251, 7, v2
    v_add_u32 v251, s3, v251
    s_mov_b64 exec, 0xff
    buffer_load_dword v252, v251, s[32:35], 0 offen
    s_mov_b64 exec, -1
L_nodwpf:
    s_cmp_lg_u32 s48, 3
    s_cbranch_scc1 L_nofpf
    s_mul_i32 s3, s50, 524288
    s_add_u32 s3, s3, 262144
    v_mov_b32 v251, s3
    s_mov_b64 exec, 1
    buffer_load_dword v252, v251, s[40:43], 0 offen sc1
    s_mov_b64 exec, -1
L_nofpf:
    s_lshr_b32 s60, s48, 1
    s_and_b32 s61, s48, 1
    s_mul_i32 s3, s60, 144
    v_add_u32 v7, s3, v6
    v_lshrrev_b32 v8, 1, v6
    v_xor_b32 v8, v8, v4
    v_lshlrev_b32 v8, 4, v8
    v_lshl_add_u32 v8, v7, 7, v8
    v_xor_b32 v9, 64, v8
    v_lshrrev_b32 v7, 2, v6
    v_and_b32 v10, 1, v4
    v_lshl_add_u32 v10, v10, 2, v7
    v_lshlrev_b32 v10, 5, v10
    v_and_b32 v11, 3, v6
    v_lshl_add_u32 v10, v11, 3, v10
    v_lshl_add_u32 v7, v4, 3, v7
    v_lshl_add_u32 v224, v7, 8, v10
    v_xor_b32 v225, 32, v224
    v_xor_b32 v226, 64, v224
    v_xor_b32 v227, 96, v224
    v_xor_b32 v228, 128, v224
    v_xor_b32 v229, 160, v224
    v_xor_b32 v230, 192, v224
    v_xor_b32 v231, 224, v224
    s_lshl_b32 s3, s61, 5
    v_xor_b32 v10, s3, v224
    v_add_u32 v10, 36864, v10
    v_xor_b32 v11, 64, v10
    v_xor_b32 v12, 128, v10
    v_xor_b32 v13, 192, v10
    v_mov_b32 v15, 163824
    v_mov_b32 v5, 1
    s_lshr_b32 s3, s18, 1
    s_lshl_b32 s3, s3, 2
    v_add_u32 v3, s3, v4
    v_lshlrev_b32 v3, 1, v3
    v_xor_b32 v3, v3, v6
    v_lshlrev_b32 v3, 4, v3
    s_lshl_b32 s3, s18, 2
    v_add_u32 v7, s3, v4
    v_lshl_add_u32 v3, v7, 10, v3
    s_lshl_b32 s3, s19, 7
    v_add_u32 v3, s3, v3
    s_lshl_b32 s74, s18, 10
    s_lshl_b32 s3, s61, 4
    v_add_u32 v7, s3, v6
    v_mul_u32_u24 v7, 592, v7
    v_lshl_add_u32 v7, v4, 3, v7
    s_mul_i32 s3, s60, 288
    s_add_u32 s3, s3, 125952
    v_add_u32 v14, s3, v7
    s_and_b32 s60, s49, 1
    s_lshr_b32 s61, s49, 1
    s_lshl_b32 s3, s60, 2
    s_add_u32 s3, s3, s48
    s_lshl_b32 s59, s3, 15
    s_mul_i32 s75, s50, 524288
    s_add_u32 s75, s75, 0
    s_add_u32 s3, s59, s75
    v_lshlrev_b32 v232, 4, v2
    v_add_u32 v232, s3, v232
    v_add_u32 v233, 16384, v232
    s_waitcnt lgkmcnt(0)
    s_add_u32 s3, s19, 0
    s_and_b32 s3, s3, 7
    s_lshl_b32 s62, s3, 11
    s_add_u32 s3, s19, 1
    s_and_b32 s3, s3, 7
    s_lshl_b32 s63, s3, 11
    s_add_u32 s3, s19, 2
    s_and_b32 s3, s3, 7
    s_lshl_b32 s64, s3, 11
    s_add_u32 s3, s19, 3
    s_and_b32 s3, s3, 7
    s_lshl_b32 s65, s3, 11
    s_add_u32 s3, s19, 4
    s_and_b32 s3, s3, 7
    s_lshl_b32 s66, s3, 11
    s_add_u32 s3, s19, 5
    s_and_b32 s3, s3, 7
    s_lshl_b32 s67, s3, 11
    s_add_u32 s3, s19, 6
    s_and_b32 s3, s3, 7
    s_lshl_b32 s68, s3, 11
    s_add_u32 s3, s19, 7
    s_and_b32 s3, s3, 7
    s_lshl_b32 s69, s3, 11
    s_mul_i32 s3, s50, 524288
    s_add_u32 s3, s3, 262144
    v_and_b32 v7, 7, v2
    v_lshlrev_b32 v234, 4, v7
    v_add_u32 v234, s3, v234
    s_lshl_b32 s3, s50, 3
    v_add_u32 v248, s3, v7
    v_lshrrev_b32 v249, 1, v7
    v_mul_u32_u24 v249, 592, v249
    v_and_b32 v7, 1, v7
    v_lshl_add_u32 v249, v7, 3, v249
    v_add_u32 v249, 161456, v249
    s_lshl_b32 s3, s48, 13
    s_add_u32 s3, s3, 131072
    v_lshrrev_b32 v235, 1, v4
    v_xor_b32 v235, v235, v6
    v_lshlrev_b32 v235, 4, v235
    v_and_b32 v7, 1, v4
    v_lshl_add_u32 v235, v7, 3, v235
    v_lshl_add_u32 v235, v6, 8, v235
    v_add_u32 v235, s3, v235
    v_xor_b32 v236, 32, v235
    v_xor_b32 v237, 64, v235
    v_xor_b32 v238, 96, v235
    v_xor_b32 v239, 128, v235
    v_xor_b32 v240, 160, v235
    v_xor_b32 v241, 192, v235
    v_xor_b32 v242, 224, v235
    v_xor_b32 v243, v6, v4
    v_lshlrev_b32 v243, 4, v243
    v_lshl_add_u32 v243, v4, 8, v243
    v_add_u32 v243, s3, v243
    v_xor_b32 v244, 64, v243
    v_xor_b32 v245, 128, v243
    v_xor_b32 v246, 192, v243
    s_lshl_b32 s75, s61, 8
    s_add_u32 s3, s59, s75
    v_lshlrev_b32 v247, 4, v6
    v_lshl_add_u32 v247, v4, 10, v247
    v_add_u32 v247, s3, v247
    s_waitcnt lgkmcnt(0)
    s_barrier
    ds_read_b64_tr_b16 v[192:193], v10 offset:0
    ds_read_b64_tr_b16 v[194:195], v10 offset:1024
    ds_read_b64_tr_b16 v[196:197], v11 offset:0
    ds_read_b64_tr_b16 v[198:199], v11 offset:1024
    ds_read_b64_tr_b16 v[200:201], v12 offset:0
    ds_read_b64_tr_b16 v[202:203], v12 offset:1024
    ds_read_b64_tr_b16 v[204:205], v13 offset:0
    ds_read_b64_tr_b16 v[206:207], v13 offset:1024
    ds_read_b128 v[160:163], v8 offset:0
    ds_read_b128 v[164:167], v8 offset:2048
    ds_read_b128 v[168:171], v8 offset:4096
    ds_read_b128 v[172:175], v8 offset:6144
    s_waitcnt lgkmcnt(3)
    v_mfma_f32_16x16x32_bf16 v[16:19], v[160:163], v[192:195], 0
    ds_read_b128 v[176:179], v8 offset:8192
    v_mfma_f32_16x16x32_bf16 v[20:23], v[160:163], v[196:199], 0
    ds_read_b128 v[180:183], v8 offset:10240
    v_mfma_f32_16x16x32_bf16 v[24:27], v[160:163], v[200:203], 0
    v_mfma_f32_16x16x32_bf16 v[28:31], v[160:163], v[204:207], 0
    s_waitcnt lgkmcnt(4)
    v_mfma_f32_16x16x32_bf16 v[32:35], v[164:167], v[192:195], 0
    ds_read_b128 v[184:187], v8 offset:12288
    v_mfma_f32_16x16x32_bf16 v[36:39], v[164:167], v[196:199], 0
    ds_read_b128 v[188:191], v8 offset:14336
    v_mfma_f32_16x16x32_bf16 v[40:43], v[164:167], v[200:203], 0
    v_mfma_f32_16x16x32_bf16 v[44:47], v[164:167], v[204:207], 0
    s_waitcnt lgkmcnt(5)
    v_mfma_f32_16x16x32_bf16 v[48:51], v[168:171], v[192:195], 0
    ds_read_b64_tr_b16 v[208:209], v10 offset:8192
    ds_read_b64_tr_b16 v[210:211], v10 offset:9216
    v_mfma_f32_16x16x32_bf16 v[52:55], v[168:171], v[196:199], 0
    ds_read_b128 v[160:163], v8 offset:16384
    v_mfma_f32_16x16x32_bf16 v[56:59], v[168:171], v[200:203], 0
    v_mfma_f32_16x16x32_bf16 v[60:63], v[168:171], v[204:207], 0
    s_waitcnt lgkmcnt(7)
    v_mfma_f32_16x16x32_bf16 v[64:67], v[172:175], v[192:195], 0
    ds_read_b64_tr_b16 v[212:213], v11 offset:8192
    ds_read_b64_tr_b16 v[214:215], v11 offset:9216
    v_mfma_f32_16x16x32_bf16 v[68:71], v[172:175], v[196:199], 0
    ds_read_b128 v[164:167], v9 offset:0
    v_mfma_f32_16x16x32_bf16 v[72:75], v[172:175], v[200:203], 0
    v_mfma_f32_16x16x32_bf16 v[76:79], v[172:175], v[204:207], 0
    s_waitcnt lgkmcnt(9)
    v_mfma_f32_16x16x32_bf16 v[80:83], v[176:179], v[192:195], 0
    ds_read_b64_tr_b16 v[216:217], v12 offset:8192
    ds_read_b64_tr_b16 v[218:219], v12 offset:9216
    v_mfma_f32_16x16x32_bf16 v[84:87], v[176:179], v[196:199], 0
    ds_read_b128 v[168:171], v9 offset:2048
    v_mfma_f32_16x16x32_bf16 v[88:91], v[176:179], v[200:203], 0
    v_mfma_f32_16x16x32_bf16 v[92:95], v[176:179], v[204:207], 0
    s_waitcnt lgkmcnt(11)
    v_mfma_f32_16x16x32_bf16 v[96:99], v[180:183], v[192:195], 0
    ds_read_b64_tr_b16 v[220:221], v13 offset:8192
    ds_read_b64_tr_b16 v[222:223], v13 offset:9216
    v_mfma_f32_16x16x32_bf16 v[100:103], v[180:183], v[196:199], 0
    ds_read_b128 v[172:175], v9 offset:4096
    v_mfma_f32_16x16x32_bf16 v[104:107], v[180:183], v[200:203], 0
    v_mfma_f32_16x16x32_bf16 v[108:111], v[180:183], v[204:207], 0
    s_waitcnt lgkmcnt(13)
    v_mfma_f32_16x16x32_bf16 v[112:115], v[184:187], v[192:195], 0
    ds_read_b128 v[176:179], v9 offset:6144
    v_mfma_f32_16x16x32_bf16 v[116:119], v[184:187], v[196:199], 0
    v_mfma_f32_16x16x32_bf16 v[120:123], v[184:187], v[200:203], 0
    v_mfma_f32_16x16x32_bf16 v[124:127], v[184:187], v[204:207], 0
    s_waitcnt lgkmcnt(13)
    v_mfma_f32_16x16x32_bf16 v[128:131], v[188:191], v[192:195], 0
    ds_read_b128 v[180:183], v9 offset:8192
    v_mfma_f32_16x16x32_bf16 v[132:135], v[188:191], v[196:199], 0
    v_mfma_f32_16x16x32_bf16 v[136:139], v[188:191], v[200:203], 0
    v_mfma_f32_16x16x32_bf16 v[140:143], v[188:191], v[204:207], 0
    s_waitcnt lgkmcnt(11)
    v_mfma_f32_16x16x32_bf16 v[144:147], v[160:163], v[192:195], 0
    ds_read_b128 v[184:187], v9 offset:10240
    v_mfma_f32_16x16x32_bf16 v[148:151], v[160:163], v[196:199], 0
    v_mfma_f32_16x16x32_bf16 v[152:155], v[160:163], v[200:203], 0
    v_mfma_f32_16x16x32_bf16 v[156:159], v[160:163], v[204:207], 0
    s_waitcnt lgkmcnt(4)
    v_mfma_f32_16x16x32_bf16 v[16:19], v[164:167], v[208:211], v[16:19]
    ds_read_b128 v[188:191], v9 offset:12288
    v_mfma_f32_16x16x32_bf16 v[20:23], v[164:167], v[212:215], v[20:23]
    ds_read_b128 v[160:163], v9 offset:14336
    v_mfma_f32_16x16x32_bf16 v[24:27], v[164:167], v[216:219], v[24:27]
    v_mfma_f32_16x16x32_bf16 v[28:31], v[164:167], v[220:223], v[28:31]
    v_mfma_f32_16x16x32_bf16 v[32:35], v[168:171], v[208:211], v[32:35]
    ds_read_b128 v[164:167], v9 offset:16384
    v_mfma_f32_16x16x32_bf16 v[36:39], v[168:171], v[212:215], v[36:39]
    v_mfma_f32_16x16x32_bf16 v[40:43], v[168:171], v[216:219], v[40:43]
    v_mfma_f32_16x16x32_bf16 v[44:47], v[168:171], v[220:223], v[44:47]
    s_waitcnt lgkmcnt(6)
    v_mfma_f32_16x16x32_bf16 v[48:51], v[172:175], v[208:211], v[48:51]
    v_mfma_f32_16x16x32_bf16 v[52:55], v[172:175], v[212:215], v[52:55]
    v_mfma_f32_16x16x32_bf16 v[56:59], v[172:175], v[216:219], v[56:59]
    v_mfma_f32_16x16x32_bf16 v[60:63], v[172:175], v[220:223], v[60:63]
    s_waitcnt lgkmcnt(5)
    v_mfma_f32_16x16x32_bf16 v[64:67], v[176:179], v[208:211], v[64:67]
    v_mfma_f32_16x16x32_bf16 v[68:71], v[176:179], v[212:215], v[68:71]
    v_mfma_f32_16x16x32_bf16 v[72:75], v[176:179], v[216:219], v[72:75]
    v_mfma_f32_16x16x32_bf16 v[76:79], v[176:179], v[220:223], v[76:79]
    s_waitcnt lgkmcnt(4)
    v_mfma_f32_16x16x32_bf16 v[80:83], v[180:183], v[208:211], v[80:83]
    v_mfma_f32_16x16x32_bf16 v[84:87], v[180:183], v[212:215], v[84:87]
    v_mfma_f32_16x16x32_bf16 v[88:91], v[180:183], v[216:219], v[88:91]
    v_mfma_f32_16x16x32_bf16 v[92:95], v[180:183], v[220:223], v[92:95]
    s_waitcnt lgkmcnt(0)
    s_barrier
    v_add_u32 v8, 53248, v8
    v_add_u32 v9, 53248, v9
    v_add_u32 v10, 53248, v10
    v_add_u32 v11, 53248, v11
    v_add_u32 v12, 53248, v12
    v_add_u32 v13, 53248, v13
    v_mfma_f32_16x16x32_bf16 v[96:99], v[184:187], v[208:211], v[96:99]
    ds_read_b64_tr_b16 v[192:193], v10 offset:0
    ds_read_b64_tr_b16 v[194:195], v10 offset:1024
    v_mfma_f32_16x16x32_bf16 v[100:103], v[184:187], v[212:215], v[100:103]
    ds_read_b64_tr_b16 v[196:197], v11 offset:0
    ds_read_b64_tr_b16 v[198:199], v11 offset:1024
    v_mfma_f32_16x16x32_bf16 v[104:107], v[184:187], v[216:219], v[104:107]
    ds_read_b128 v[168:171], v8 offset:0
    v_mfma_f32_16x16x32_bf16 v[108:111], v[184:187], v[220:223], v[108:111]
    ds_read_b128 v[172:175], v8 offset:2048
    v_mfma_f32_16x16x32_bf16 v[112:115], v[188:191], v[208:211], v[112:115]
    ds_read_b64_tr_b16 v[200:201], v12 offset:0
    ds_read_b64_tr_b16 v[202:203], v12 offset:1024
    v_mfma_f32_16x16x32_bf16 v[116:119], v[188:191], v[212:215], v[116:119]
    ds_read_b64_tr_b16 v[204:205], v13 offset:0
    ds_read_b64_tr_b16 v[206:207], v13 offset:1024
    v_mfma_f32_16x16x32_bf16 v[120:123], v[188:191], v[216:219], v[120:123]
    ds_read_b128 v[176:179], v8 offset:4096
    v_mfma_f32_16x16x32_bf16 v[124:127], v[188:191], v[220:223], v[124:127]
    ds_read_b128 v[180:183], v8 offset:6144
    v_mfma_f32_16x16x32_bf16 v[128:131], v[160:163], v[208:211], v[128:131]
    ds_read_b128 v[184:187], v8 offset:8192
    v_mfma_f32_16x16x32_bf16 v[132:135], v[160:163], v[212:215], v[132:135]
    ds_read_b128 v[188:191], v8 offset:10240
    v_mfma_f32_16x16x32_bf16 v[136:139], v[160:163], v[216:219], v[136:139]
    v_mfma_f32_16x16x32_bf16 v[140:143], v[160:163], v[220:223], v[140:143]
    v_mfma_f32_16x16x32_bf16 v[144:147], v[164:167], v[208:211], v[144:147]
    ds_read_b128 v[160:163], v8 offset:12288
    v_mfma_f32_16x16x32_bf16 v[148:151], v[164:167], v[212:215], v[148:151]
    v_mfma_f32_16x16x32_bf16 v[152:155], v[164:167], v[216:219], v[152:155]
    v_mfma_f32_16x16x32_bf16 v[156:159], v[164:167], v[220:223], v[156:159]
    s_waitcnt lgkmcnt(5)
    v_mfma_f32_16x16x32_bf16 v[16:19], v[168:171], v[192:195], v[16:19]
    v_mfma_f32_16x16x32_bf16 v[20:23], v[168:171], v[196:199], v[20:23]
    v_mfma_f32_16x16x32_bf16 v[24:27], v[168:171], v[200:203], v[24:27]
    v_mfma_f32_16x16x32_bf16 v[28:31], v[168:171], v[204:207], v[28:31]
    v_mfma_f32_16x16x32_bf16 v[32:35], v[172:175], v[192:195], v[32:35]
    ds_read_b128 v[164:167], v8 offset:14336
    v_mfma_f32_16x16x32_bf16 v[36:39], v[172:175], v[196:199], v[36:39]
    v_mfma_f32_16x16x32_bf16 v[40:43], v[172:175], v[200:203], v[40:43]
    v_mfma_f32_16x16x32_bf16 v[44:47], v[172:175], v[204:207], v[44:47]
    s_waitcnt lgkmcnt(5)
    v_mfma_f32_16x16x32_bf16 v[48:51], v[176:179], v[192:195], v[48:51]
    ds_read_b64_tr_b16 v[208:209], v10 offset:8192
    ds_read_b64_tr_b16 v[210:211], v10 offset:9216
    v_mfma_f32_16x16x32_bf16 v[52:55], v[176:179], v[196:199], v[52:55]
    ds_read_b128 v[168:171], v8 offset:16384
    v_mfma_f32_16x16x32_bf16 v[56:59], v[176:179], v[200:203], v[56:59]
    v_mfma_f32_16x16x32_bf16 v[60:63], v[176:179], v[204:207], v[60:63]
    s_waitcnt lgkmcnt(7)
    v_mfma_f32_16x16x32_bf16 v[64:67], v[180:183], v[192:195], v[64:67]
    ds_read_b64_tr_b16 v[212:213], v11 offset:8192
    ds_read_b64_tr_b16 v[214:215], v11 offset:9216
    v_mfma_f32_16x16x32_bf16 v[68:71], v[180:183], v[196:199], v[68:71]
    ds_read_b128 v[172:175], v9 offset:0
    v_mfma_f32_16x16x32_bf16 v[72:75], v[180:183], v[200:203], v[72:75]
    v_mfma_f32_16x16x32_bf16 v[76:79], v[180:183], v[204:207], v[76:79]
    s_waitcnt lgkmcnt(9)
    v_mfma_f32_16x16x32_bf16 v[80:83], v[184:187], v[192:195], v[80:83]
    ds_read_b64_tr_b16 v[216:217], v12 offset:8192
    ds_read_b64_tr_b16 v[218:219], v12 offset:9216
    v_mfma_f32_16x16x32_bf16 v[84:87], v[184:187], v[196:199], v[84:87]
    ds_read_b128 v[176:179], v9 offset:2048
    v_mfma_f32_16x16x32_bf16 v[88:91], v[184:187], v[200:203], v[88:91]
    v_mfma_f32_16x16x32_bf16 v[92:95], v[184:187], v[204:207], v[92:95]
    s_waitcnt lgkmcnt(11)
    v_mfma_f32_16x16x32_bf16 v[96:99], v[188:191], v[192:195], v[96:99]
    ds_read_b64_tr_b16 v[220:221], v13 offset:8192
    ds_read_b64_tr_b16 v[222:223], v13 offset:9216
    v_mfma_f32_16x16x32_bf16 v[100:103], v[188:191], v[196:199], v[100:103]
    ds_read_b128 v[180:183], v9 offset:4096
    v_mfma_f32_16x16x32_bf16 v[104:107], v[188:191], v[200:203], v[104:107]
    v_mfma_f32_16x16x32_bf16 v[108:111], v[188:191], v[204:207], v[108:111]
    s_waitcnt lgkmcnt(13)
    v_mfma_f32_16x16x32_bf16 v[112:115], v[160:163], v[192:195], v[112:115]
    ds_read_b128 v[184:187], v9 offset:6144
    v_mfma_f32_16x16x32_bf16 v[116:119], v[160:163], v[196:199], v[116:119]
    v_mfma_f32_16x16x32_bf16 v[120:123], v[160:163], v[200:203], v[120:123]
    v_mfma_f32_16x16x32_bf16 v[124:127], v[160:163], v[204:207], v[124:127]
    s_waitcnt lgkmcnt(13)
    v_mfma_f32_16x16x32_bf16 v[128:131], v[164:167], v[192:195], v[128:131]
    ds_read_b128 v[188:191], v9 offset:8192
    v_mfma_f32_16x16x32_bf16 v[132:135], v[164:167], v[196:199], v[132:135]
    v_mfma_f32_16x16x32_bf16 v[136:139], v[164:167], v[200:203], v[136:139]
    v_mfma_f32_16x16x32_bf16 v[140:143], v[164:167], v[204:207], v[140:143]
    s_waitcnt lgkmcnt(11)
    v_mfma_f32_16x16x32_bf16 v[144:147], v[168:171], v[192:195], v[144:147]
    ds_read_b128 v[160:163], v9 offset:10240
    v_mfma_f32_16x16x32_bf16 v[148:151], v[168:171], v[196:199], v[148:151]
    v_mfma_f32_16x16x32_bf16 v[152:155], v[168:171], v[200:203], v[152:155]
    v_mfma_f32_16x16x32_bf16 v[156:159], v[168:171], v[204:207], v[156:159]
    s_waitcnt lgkmcnt(4)
    v_mfma_f32_16x16x32_bf16 v[16:19], v[172:175], v[208:211], v[16:19]
    ds_read_b128 v[164:167], v9 offset:12288
    v_mfma_f32_16x16x32_bf16 v[20:23], v[172:175], v[212:215], v[20:23]
    ds_read_b128 v[168:171], v9 offset:14336
    v_mfma_f32_16x16x32_bf16 v[24:27], v[172:175], v[216:219], v[24:27]
    v_mfma_f32_16x16x32_bf16 v[28:31], v[172:175], v[220:223], v[28:31]
    v_mfma_f32_16x16x32_bf16 v[32:35], v[176:179], v[208:211], v[32:35]
    ds_read_b128 v[172:175], v9 offset:16384
    v_mfma_f32_16x16x32_bf16 v[36:39], v[176:179], v[212:215], v[36:39]
    v_mfma_f32_16x16x32_bf16 v[40:43], v[176:179], v[216:219], v[40:43]
    v_mfma_f32_16x16x32_bf16 v[44:47], v[176:179], v[220:223], v[44:47]
    s_waitcnt lgkmcnt(6)
    v_mfma_f32_16x16x32_bf16 v[48:51], v[180:183], v[208:211], v[48:51]
    v_mfma_f32_16x16x32_bf16 v[52:55], v[180:183], v[212:215], v[52:55]
    v_mfma_f32_16x16x32_bf16 v[56:59], v[180:183], v[216:219], v[56:59]
    v_mfma_f32_16x16x32_bf16 v[60:63], v[180:183], v[220:223], v[60:63]
    s_waitcnt lgkmcnt(5)
    v_mfma_f32_16x16x32_bf16 v[64:67], v[184:187], v[208:211], v[64:67]
    v_mfma_f32_16x16x32_bf16 v[68:71], v[184:187], v[212:215], v[68:71]
    v_mfma_f32_16x16x32_bf16 v[72:75], v[184:187], v[216:219], v[72:75]
    v_mfma_f32_16x16x32_bf16 v[76:79], v[184:187], v[220:223], v[76:79]
    s_waitcnt lgkmcnt(4)
    v_mfma_f32_16x16x32_bf16 v[80:83], v[188:191], v[208:211], v[80:83]
    v_mfma_f32_16x16x32_bf16 v[84:87], v[188:191], v[212:215], v[84:87]
    v_mfma_f32_16x16x32_bf16 v[88:91], v[188:191], v[216:219], v[88:91]
    v_mfma_f32_16x16x32_bf16 v[92:95], v[188:191], v[220:223], v[92:95]
    s_waitcnt lgkmcnt(0)
    s_barrier
    v_add_u32 v8, 53248, v8
    v_add_u32 v9, 53248, v9
    v_add_u32 v10, 53248, v10
    v_add_u32 v11, 53248, v11
    v_add_u32 v12, 53248, v12
    v_add_u32 v13, 53248, v13
    v_mfma_f32_16x16x32_bf16 v[96:99], v[160:163], v[208:211], v[96:99]
    ds_read_b64_tr_b16 v[192:193], v10 offset:0
    ds_read_b64_tr_b16 v[194:195], v10 offset:1024
    v_mfma_f32_16x16x32_bf16 v[100:103], v[160:163], v[212:215], v[100:103]
    ds_read_b64_tr_b16 v[196:197], v11 offset:0
    ds_read_b64_tr_b16 v[198:199], v11 offset:1024
    v_mfma_f32_16x16x32_bf16 v[104:107], v[160:163], v[216:219], v[104:107]
    ds_read_b128 v[176:179], v8 offset:0
    v_mfma_f32_16x16x32_bf16 v[108:111], v[160:163], v[220:223], v[108:111]
    ds_read_b128 v[180:183], v8 offset:2048
    v_mfma_f32_16x16x32_bf16 v[112:115], v[164:167], v[208:211], v[112:115]
    ds_read_b64_tr_b16 v[200:201], v12 offset:0
    ds_read_b64_tr_b16 v[202:203], v12 offset:1024
    v_mfma_f32_16x16x32_bf16 v[116:119], v[164:167], v[212:215], v[116:119]
    ds_read_b64_tr_b16 v[204:205], v13 offset:0
    ds_read_b64_tr_b16 v[206:207], v13 offset:1024
    v_mfma_f32_16x16x32_bf16 v[120:123], v[164:167], v[216:219], v[120:123]
    ds_read_b128 v[184:187], v8 offset:4096
    v_mfma_f32_16x16x32_bf16 v[124:127], v[164:167], v[220:223], v[124:127]
    ds_read_b128 v[188:191], v8 offset:6144
    v_mfma_f32_16x16x32_bf16 v[128:131], v[168:171], v[208:211], v[128:131]
    ds_read_b128 v[160:163], v8 offset:8192
    v_mfma_f32_16x16x32_bf16 v[132:135], v[168:171], v[212:215], v[132:135]
    ds_read_b128 v[164:167], v8 offset:10240
    v_mfma_f32_16x16x32_bf16 v[136:139], v[168:171], v[216:219], v[136:139]
    v_mfma_f32_16x16x32_bf16 v[140:143], v[168:171], v[220:223], v[140:143]
    v_mfma_f32_16x16x32_bf16 v[144:147], v[172:175], v[208:211], v[144:147]
    ds_read_b128 v[168:171], v8 offset:12288
    v_mfma_f32_16x16x32_bf16 v[148:151], v[172:175], v[212:215], v[148:151]
    v_mfma_f32_16x16x32_bf16 v[152:155], v[172:175], v[216:219], v[152:155]
    v_mfma_f32_16x16x32_bf16 v[156:159], v[172:175], v[220:223], v[156:159]
    s_waitcnt lgkmcnt(5)
    v_mfma_f32_16x16x32_bf16 v[16:19], v[176:179], v[192:195], v[16:19]
    v_mfma_f32_16x16x32_bf16 v[20:23], v[176:179], v[196:199], v[20:23]
    v_mfma_f32_16x16x32_bf16 v[24:27], v[176:179], v[200:203], v[24:27]
    v_mfma_f32_16x16x32_bf16 v[28:31], v[176:179], v[204:207], v[28:31]
    v_mfma_f32_16x16x32_bf16 v[32:35], v[180:183], v[192:195], v[32:35]
    ds_read_b128 v[172:175], v8 offset:14336
    v_mfma_f32_16x16x32_bf16 v[36:39], v[180:183], v[196:199], v[36:39]
    v_mfma_f32_16x16x32_bf16 v[40:43], v[180:183], v[200:203], v[40:43]
    v_mfma_f32_16x16x32_bf16 v[44:47], v[180:183], v[204:207], v[44:47]
    s_waitcnt lgkmcnt(5)
    v_mfma_f32_16x16x32_bf16 v[48:51], v[184:187], v[192:195], v[48:51]
    ds_read_b64_tr_b16 v[208:209], v10 offset:8192
    ds_read_b64_tr_b16 v[210:211], v10 offset:9216
    v_mfma_f32_16x16x32_bf16 v[52:55], v[184:187], v[196:199], v[52:55]
    ds_read_b128 v[176:179], v8 offset:16384
    v_mfma_f32_16x16x32_bf16 v[56:59], v[184:187], v[200:203], v[56:59]
    v_mfma_f32_16x16x32_bf16 v[60:63], v[184:187], v[204:207], v[60:63]
    s_waitcnt lgkmcnt(7)
    v_mfma_f32_16x16x32_bf16 v[64:67], v[188:191], v[192:195], v[64:67]
    ds_read_b64_tr_b16 v[212:213], v11 offset:8192
    ds_read_b64_tr_b16 v[214:215], v11 offset:9216
    v_mfma_f32_16x16x32_bf16 v[68:71], v[188:191], v[196:199], v[68:71]
    ds_read_b128 v[180:183], v9 offset:0
    v_mfma_f32_16x16x32_bf16 v[72:75], v[188:191], v[200:203], v[72:75]
    v_mfma_f32_16x16x32_bf16 v[76:79], v[188:191], v[204:207], v[76:79]
    s_waitcnt lgkmcnt(9)
    v_mfma_f32_16x16x32_bf16 v[80:83], v[160:163], v[192:195], v[80:83]
    ds_read_b64_tr_b16 v[216:217], v12 offset:8192
    ds_read_b64_tr_b16 v[218:219], v12 offset:9216
    v_mfma_f32_16x16x32_bf16 v[84:87], v[160:163], v[196:199], v[84:87]
    ds_read_b128 v[184:187], v9 offset:2048
    v_mfma_f32_16x16x32_bf16 v[88:91], v[160:163], v[200:203], v[88:91]
    v_mfma_f32_16x16x32_bf16 v[92:95], v[160:163], v[204:207], v[92:95]
    s_waitcnt lgkmcnt(11)
    v_mfma_f32_16x16x32_bf16 v[96:99], v[164:167], v[192:195], v[96:99]
    ds_read_b64_tr_b16 v[220:221], v13 offset:8192
    ds_read_b64_tr_b16 v[222:223], v13 offset:9216
    v_mfma_f32_16x16x32_bf16 v[100:103], v[164:167], v[196:199], v[100:103]
    ds_read_b128 v[188:191], v9 offset:4096
    v_mfma_f32_16x16x32_bf16 v[104:107], v[164:167], v[200:203], v[104:107]
    v_mfma_f32_16x16x32_bf16 v[108:111], v[164:167], v[204:207], v[108:111]
    s_waitcnt lgkmcnt(13)
    v_mfma_f32_16x16x32_bf16 v[112:115], v[168:171], v[192:195], v[112:115]
    ds_read_b128 v[160:163], v9 offset:6144
    v_mfma_f32_16x16x32_bf16 v[116:119], v[168:171], v[196:199], v[116:119]
    v_mfma_f32_16x16x32_bf16 v[120:123], v[168:171], v[200:203], v[120:123]
    v_mfma_f32_16x16x32_bf16 v[124:127], v[168:171], v[204:207], v[124:127]
    s_waitcnt lgkmcnt(13)
    v_mfma_f32_16x16x32_bf16 v[128:131], v[172:175], v[192:195], v[128:131]
    ds_read_b128 v[164:167], v9 offset:8192
    v_mfma_f32_16x16x32_bf16 v[132:135], v[172:175], v[196:199], v[132:135]
    v_mfma_f32_16x16x32_bf16 v[136:139], v[172:175], v[200:203], v[136:139]
    v_mfma_f32_16x16x32_bf16 v[140:143], v[172:175], v[204:207], v[140:143]
    s_waitcnt lgkmcnt(11)
    v_mfma_f32_16x16x32_bf16 v[144:147], v[176:179], v[192:195], v[144:147]
    ds_read_b128 v[168:171], v9 offset:10240
    v_mfma_f32_16x16x32_bf16 v[148:151], v[176:179], v[196:199], v[148:151]
    v_mfma_f32_16x16x32_bf16 v[152:155], v[176:179], v[200:203], v[152:155]
    v_mfma_f32_16x16x32_bf16 v[156:159], v[176:179], v[204:207], v[156:159]
    s_waitcnt lgkmcnt(4)
    v_mfma_f32_16x16x32_bf16 v[16:19], v[180:183], v[208:211], v[16:19]
    ds_read_b128 v[172:175], v9 offset:12288
    v_mfma_f32_16x16x32_bf16 v[20:23], v[180:183], v[212:215], v[20:23]
    ds_read_b128 v[176:179], v9 offset:14336
    v_mfma_f32_16x16x32_bf16 v[24:27], v[180:183], v[216:219], v[24:27]
    v_mfma_f32_16x16x32_bf16 v[28:31], v[180:183], v[220:223], v[28:31]
    v_mfma_f32_16x16x32_bf16 v[32:35], v[184:187], v[208:211], v[32:35]
    ds_read_b128 v[180:183], v9 offset:16384
    v_mfma_f32_16x16x32_bf16 v[36:39], v[184:187], v[212:215], v[36:39]
    v_mfma_f32_16x16x32_bf16 v[40:43], v[184:187], v[216:219], v[40:43]
    v_mfma_f32_16x16x32_bf16 v[44:47], v[184:187], v[220:223], v[44:47]
    s_waitcnt lgkmcnt(6)
    v_mfma_f32_16x16x32_bf16 v[48:51], v[188:191], v[208:211], v[48:51]
    v_mfma_f32_16x16x32_bf16 v[52:55], v[188:191], v[212:215], v[52:55]
    v_mfma_f32_16x16x32_bf16 v[56:59], v[188:191], v[216:219], v[56:59]
    v_mfma_f32_16x16x32_bf16 v[60:63], v[188:191], v[220:223], v[60:63]
    s_waitcnt lgkmcnt(5)
    v_mfma_f32_16x16x32_bf16 v[64:67], v[160:163], v[208:211], v[64:67]
    v_mfma_f32_16x16x32_bf16 v[68:71], v[160:163], v[212:215], v[68:71]
    v_mfma_f32_16x16x32_bf16 v[72:75], v[160:163], v[216:219], v[72:75]
    v_mfma_f32_16x16x32_bf16 v[76:79], v[160:163], v[220:223], v[76:79]
    s_waitcnt lgkmcnt(4)
    v_mfma_f32_16x16x32_bf16 v[80:83], v[164:167], v[208:211], v[80:83]
    v_mfma_f32_16x16x32_bf16 v[84:87], v[164:167], v[212:215], v[84:87]
    v_mfma_f32_16x16x32_bf16 v[88:91], v[164:167], v[216:219], v[88:91]
    v_mfma_f32_16x16x32_bf16 v[92:95], v[164:167], v[220:223], v[92:95]
    s_waitcnt lgkmcnt(0)
    s_barrier
    v_subrev_u32 v8, 106496, v8
    v_subrev_u32 v9, 106496, v9
    v_subrev_u32 v10, 106496, v10
    v_subrev_u32 v11, 106496, v11
    v_subrev_u32 v12, 106496, v12
    v_subrev_u32 v13, 106496, v13
    v_mfma_f32_16x16x32_bf16 v[96:99], v[168:171], v[208:211], v[96:99]
    ds_read_b64_tr_b16 v[192:193], v10 offset:0
    ds_read_b64_tr_b16 v[194:195], v10 offset:1024
    v_mfma_f32_16x16x32_bf16 v[100:103], v[168:171], v[212:215], v[100:103]
    ds_read_b64_tr_b16 v[196:197], v11 offset:0
    ds_read_b64_tr_b16 v[198:199], v11 offset:1024
    v_mfma_f32_16x16x32_bf16 v[104:107], v[168:171], v[216:219], v[104:107]
    ds_read_b128 v[184:187], v8 offset:0
    v_mfma_f32_16x16x32_bf16 v[108:111], v[168:171], v[220:223], v[108:111]
    ds_read_b128 v[188:191], v8 offset:2048
    v_mfma_f32_16x16x32_bf16 v[112:115], v[172:175], v[208:211], v[112:115]
    ds_read_b64_tr_b16 v[200:201], v12 offset:0
    ds_read_b64_tr_b16 v[202:203], v12 offset:1024
    v_mfma_f32_16x16x32_bf16 v[116:119], v[172:175], v[212:215], v[116:119]
    ds_read_b64_tr_b16 v[204:205], v13 offset:0
    ds_read_b64_tr_b16 v[206:207], v13 offset:1024
    v_mfma_f32_16x16x32_bf16 v[120:123], v[172:175], v[216:219], v[120:123]
    ds_read_b128 v[160:163], v8 offset:4096
    v_mfma_f32_16x16x32_bf16 v[124:127], v[172:175], v[220:223], v[124:127]
    ds_read_b128 v[164:167], v8 offset:6144
    v_mfma_f32_16x16x32_bf16 v[128:131], v[176:179], v[208:211], v[128:131]
    ds_read_b128 v[168:171], v8 offset:8192
    v_mfma_f32_16x16x32_bf16 v[132:135], v[176:179], v[212:215], v[132:135]
    ds_read_b128 v[172:175], v8 offset:10240
    v_mfma_f32_16x16x32_bf16 v[136:139], v[176:179], v[216:219], v[136:139]
    v_mfma_f32_16x16x32_bf16 v[140:143], v[176:179], v[220:223], v[140:143]
    v_mfma_f32_16x16x32_bf16 v[144:147], v[180:183], v[208:211], v[144:147]
    ds_read_b128 v[176:179], v8 offset:12288
    v_mfma_f32_16x16x32_bf16 v[148:151], v[180:183], v[212:215], v[148:151]
    v_mfma_f32_16x16x32_bf16 v[152:155], v[180:183], v[216:219], v[152:155]
    v_mfma_f32_16x16x32_bf16 v[156:159], v[180:183], v[220:223], v[156:159]
    s_waitcnt lgkmcnt(5)
    v_mfma_f32_16x16x32_bf16 v[16:19], v[184:187], v[192:195], v[16:19]
    v_mfma_f32_16x16x32_bf16 v[20:23], v[184:187], v[196:199], v[20:23]
    v_mfma_f32_16x16x32_bf16 v[24:27], v[184:187], v[200:203], v[24:27]
    v_mfma_f32_16x16x32_bf16 v[28:31], v[184:187], v[204:207], v[28:31]
    v_mfma_f32_16x16x32_bf16 v[32:35], v[188:191], v[192:195], v[32:35]
    ds_read_b128 v[180:183], v8 offset:14336
    v_mfma_f32_16x16x32_bf16 v[36:39], v[188:191], v[196:199], v[36:39]
    v_mfma_f32_16x16x32_bf16 v[40:43], v[188:191], v[200:203], v[40:43]
    v_mfma_f32_16x16x32_bf16 v[44:47], v[188:191], v[204:207], v[44:47]
    s_waitcnt lgkmcnt(5)
    v_mfma_f32_16x16x32_bf16 v[48:51], v[160:163], v[192:195], v[48:51]
    ds_read_b64_tr_b16 v[208:209], v10 offset:8192
    ds_read_b64_tr_b16 v[210:211], v10 offset:9216
    v_mfma_f32_16x16x32_bf16 v[52:55], v[160:163], v[196:199], v[52:55]
    ds_read_b128 v[184:187], v8 offset:16384
    v_mfma_f32_16x16x32_bf16 v[56:59], v[160:163], v[200:203], v[56:59]
    v_mfma_f32_16x16x32_bf16 v[60:63], v[160:163], v[204:207], v[60:63]
    s_waitcnt lgkmcnt(7)
    v_mfma_f32_16x16x32_bf16 v[64:67], v[164:167], v[192:195], v[64:67]
    ds_read_b64_tr_b16 v[212:213], v11 offset:8192
    ds_read_b64_tr_b16 v[214:215], v11 offset:9216
    v_mfma_f32_16x16x32_bf16 v[68:71], v[164:167], v[196:199], v[68:71]
    ds_read_b128 v[188:191], v9 offset:0
    v_mfma_f32_16x16x32_bf16 v[72:75], v[164:167], v[200:203], v[72:75]
    v_mfma_f32_16x16x32_bf16 v[76:79], v[164:167], v[204:207], v[76:79]
    s_waitcnt lgkmcnt(9)
    v_mfma_f32_16x16x32_bf16 v[80:83], v[168:171], v[192:195], v[80:83]
    ds_read_b64_tr_b16 v[216:217], v12 offset:8192
    ds_read_b64_tr_b16 v[218:219], v12 offset:9216
    v_mfma_f32_16x16x32_bf16 v[84:87], v[168:171], v[196:199], v[84:87]
    ds_read_b128 v[160:163], v9 offset:2048
    v_mfma_f32_16x16x32_bf16 v[88:91], v[168:171], v[200:203], v[88:91]
    v_mfma_f32_16x16x32_bf16 v[92:95], v[168:171], v[204:207], v[92:95]
    s_waitcnt lgkmcnt(11)
    v_mfma_f32_16x16x32_bf16 v[96:99], v[172:175], v[192:195], v[96:99]
    ds_read_b64_tr_b16 v[220:221], v13 offset:8192
    ds_read_b64_tr_b16 v[222:223], v13 offset:9216
    v_mfma_f32_16x16x32_bf16 v[100:103], v[172:175], v[196:199], v[100:103]
    ds_read_b128 v[164:167], v9 offset:4096
    v_mfma_f32_16x16x32_bf16 v[104:107], v[172:175], v[200:203], v[104:107]
    v_mfma_f32_16x16x32_bf16 v[108:111], v[172:175], v[204:207], v[108:111]
    s_waitcnt lgkmcnt(13)
    v_mfma_f32_16x16x32_bf16 v[112:115], v[176:179], v[192:195], v[112:115]
    ds_read_b128 v[168:171], v9 offset:6144
    v_mfma_f32_16x16x32_bf16 v[116:119], v[176:179], v[196:199], v[116:119]
    v_mfma_f32_16x16x32_bf16 v[120:123], v[176:179], v[200:203], v[120:123]
    v_mfma_f32_16x16x32_bf16 v[124:127], v[176:179], v[204:207], v[124:127]
    s_waitcnt lgkmcnt(13)
    v_mfma_f32_16x16x32_bf16 v[128:131], v[180:183], v[192:195], v[128:131]
    ds_read_b128 v[172:175], v9 offset:8192
    v_mfma_f32_16x16x32_bf16 v[132:135], v[180:183], v[196:199], v[132:135]
    v_mfma_f32_16x16x32_bf16 v[136:139], v[180:183], v[200:203], v[136:139]
    v_mfma_f32_16x16x32_bf16 v[140:143], v[180:183], v[204:207], v[140:143]
    s_waitcnt lgkmcnt(11)
    v_mfma_f32_16x16x32_bf16 v[144:147], v[184:187], v[192:195], v[144:147]
    ds_read_b128 v[176:179], v9 offset:10240
    v_mfma_f32_16x16x32_bf16 v[148:151], v[184:187], v[196:199], v[148:151]
    v_mfma_f32_16x16x32_bf16 v[152:155], v[184:187], v[200:203], v[152:155]
    v_mfma_f32_16x16x32_bf16 v[156:159], v[184:187], v[204:207], v[156:159]
    s_waitcnt lgkmcnt(4)
    v_mfma_f32_16x16x32_bf16 v[16:19], v[188:191], v[208:211], v[16:19]
    ds_read_b128 v[180:183], v9 offset:12288
    v_mfma_f32_16x16x32_bf16 v[20:23], v[188:191], v[212:215], v[20:23]
    ds_read_b128 v[184:187], v9 offset:14336
    v_mfma_f32_16x16x32_bf16 v[24:27], v[188:191], v[216:219], v[24:27]
    v_mfma_f32_16x16x32_bf16 v[28:31], v[188:191], v[220:223], v[28:31]
    v_mfma_f32_16x16x32_bf16 v[32:35], v[160:163], v[208:211], v[32:35]
    ds_read_b128 v[188:191], v9 offset:16384
    v_mfma_f32_16x16x32_bf16 v[36:39], v[160:163], v[212:215], v[36:39]
    v_mfma_f32_16x16x32_bf16 v[40:43], v[160:163], v[216:219], v[40:43]
    v_mfma_f32_16x16x32_bf16 v[44:47], v[160:163], v[220:223], v[44:47]
    s_waitcnt lgkmcnt(6)
    v_mfma_f32_16x16x32_bf16 v[48:51], v[164:167], v[208:211], v[48:51]
    v_mfma_f32_16x16x32_bf16 v[52:55], v[164:167], v[212:215], v[52:55]
    v_mfma_f32_16x16x32_bf16 v[56:59], v[164:167], v[216:219], v[56:59]
    v_mfma_f32_16x16x32_bf16 v[60:63], v[164:167], v[220:223], v[60:63]
    s_waitcnt lgkmcnt(5)
    v_mfma_f32_16x16x32_bf16 v[64:67], v[168:171], v[208:211], v[64:67]
    v_mfma_f32_16x16x32_bf16 v[68:71], v[168:171], v[212:215], v[68:71]
    v_mfma_f32_16x16x32_bf16 v[72:75], v[168:171], v[216:219], v[72:75]
    v_mfma_f32_16x16x32_bf16 v[76:79], v[168:171], v[220:223], v[76:79]
    s_waitcnt lgkmcnt(4)
    v_mfma_f32_16x16x32_bf16 v[80:83], v[172:175], v[208:211], v[80:83]
    v_mfma_f32_16x16x32_bf16 v[84:87], v[172:175], v[212:215], v[84:87]
    v_mfma_f32_16x16x32_bf16 v[88:91], v[172:175], v[216:219], v[88:91]
    v_mfma_f32_16x16x32_bf16 v[92:95], v[172:175], v[220:223], v[92:95]
    s_waitcnt lgkmcnt(0)
    s_barrier
    v_add_u32 v8, 53248, v8
    v_add_u32 v9, 53248, v9
    v_add_u32 v10, 53248, v10
    v_add_u32 v11, 53248, v11
    v_add_u32 v12, 53248, v12
    v_add_u32 v13, 53248, v13
    v_mfma_f32_16x16x32_bf16 v[96:99], v[176:179], v[208:211], v[96:99]
    ds_read_b64_tr_b16 v[192:193], v10 offset:0
    ds_read_b64_tr_b16 v[194:195], v10 offset:1024
    v_mfma_f32_16x16x32_bf16 v[100:103], v[176:179], v[212:215], v[100:103]
    ds_read_b64_tr_b16 v[196:197], v11 offset:0
    ds_read_b64_tr_b16 v[198:199], v11 offset:1024
    v_mfma_f32_16x16x32_bf16 v[104:107], v[176:179], v[216:219], v[104:107]
    ds_read_b128 v[160:163], v8 offset:0
    v_mfma_f32_16x16x32_bf16 v[108:111], v[176:179], v[220:223], v[108:111]
    ds_read_b128 v[164:167], v8 offset:2048
    v_mfma_f32_16x16x32_bf16 v[112:115], v[180:183], v[208:211], v[112:115]
    ds_read_b64_tr_b16 v[200:201], v12 offset:0
    ds_read_b64_tr_b16 v[202:203], v12 offset:1024
    v_mfma_f32_16x16x32_bf16 v[116:119], v[180:183], v[212:215], v[116:119]
    ds_read_b64_tr_b16 v[204:205], v13 offset:0
    ds_read_b64_tr_b16 v[206:207], v13 offset:1024
    v_mfma_f32_16x16x32_bf16 v[120:123], v[180:183], v[216:219], v[120:123]
    ds_read_b128 v[168:171], v8 offset:4096
    v_mfma_f32_16x16x32_bf16 v[124:127], v[180:183], v[220:223], v[124:127]
    ds_read_b128 v[172:175], v8 offset:6144
    v_mfma_f32_16x16x32_bf16 v[128:131], v[184:187], v[208:211], v[128:131]
    ds_read_b128 v[176:179], v8 offset:8192
    v_mfma_f32_16x16x32_bf16 v[132:135], v[184:187], v[212:215], v[132:135]
    ds_read_b128 v[180:183], v8 offset:10240
    v_mfma_f32_16x16x32_bf16 v[136:139], v[184:187], v[216:219], v[136:139]
    v_mfma_f32_16x16x32_bf16 v[140:143], v[184:187], v[220:223], v[140:143]
    v_mfma_f32_16x16x32_bf16 v[144:147], v[188:191], v[208:211], v[144:147]
    ds_read_b128 v[184:187], v8 offset:12288
    v_mfma_f32_16x16x32_bf16 v[148:151], v[188:191], v[212:215], v[148:151]
    v_mfma_f32_16x16x32_bf16 v[152:155], v[188:191], v[216:219], v[152:155]
    v_mfma_f32_16x16x32_bf16 v[156:159], v[188:191], v[220:223], v[156:159]
    s_waitcnt lgkmcnt(5)
    v_mfma_f32_16x16x32_bf16 v[16:19], v[160:163], v[192:195], v[16:19]
    v_mfma_f32_16x16x32_bf16 v[20:23], v[160:163], v[196:199], v[20:23]
    v_mfma_f32_16x16x32_bf16 v[24:27], v[160:163], v[200:203], v[24:27]
    v_mfma_f32_16x16x32_bf16 v[28:31], v[160:163], v[204:207], v[28:31]
    v_mfma_f32_16x16x32_bf16 v[32:35], v[164:167], v[192:195], v[32:35]
    ds_read_b128 v[188:191], v8 offset:14336
    v_mfma_f32_16x16x32_bf16 v[36:39], v[164:167], v[196:199], v[36:39]
    v_mfma_f32_16x16x32_bf16 v[40:43], v[164:167], v[200:203], v[40:43]
    v_mfma_f32_16x16x32_bf16 v[44:47], v[164:167], v[204:207], v[44:47]
    s_waitcnt lgkmcnt(5)
    v_mfma_f32_16x16x32_bf16 v[48:51], v[168:171], v[192:195], v[48:51]
    ds_read_b64_tr_b16 v[208:209], v10 offset:8192
    ds_read_b64_tr_b16 v[210:211], v10 offset:9216
    v_mfma_f32_16x16x32_bf16 v[52:55], v[168:171], v[196:199], v[52:55]
    ds_read_b128 v[160:163], v8 offset:16384
    v_mfma_f32_16x16x32_bf16 v[56:59], v[168:171], v[200:203], v[56:59]
    v_mfma_f32_16x16x32_bf16 v[60:63], v[168:171], v[204:207], v[60:63]
    s_waitcnt lgkmcnt(7)
    v_mfma_f32_16x16x32_bf16 v[64:67], v[172:175], v[192:195], v[64:67]
    ds_read_b64_tr_b16 v[212:213], v11 offset:8192
    ds_read_b64_tr_b16 v[214:215], v11 offset:9216
    v_mfma_f32_16x16x32_bf16 v[68:71], v[172:175], v[196:199], v[68:71]
    ds_read_b128 v[164:167], v9 offset:0
    v_mfma_f32_16x16x32_bf16 v[72:75], v[172:175], v[200:203], v[72:75]
    v_mfma_f32_16x16x32_bf16 v[76:79], v[172:175], v[204:207], v[76:79]
    s_waitcnt lgkmcnt(9)
    v_mfma_f32_16x16x32_bf16 v[80:83], v[176:179], v[192:195], v[80:83]
    ds_read_b64_tr_b16 v[216:217], v12 offset:8192
    ds_read_b64_tr_b16 v[218:219], v12 offset:9216
    v_mfma_f32_16x16x32_bf16 v[84:87], v[176:179], v[196:199], v[84:87]
    ds_read_b128 v[168:171], v9 offset:2048
    v_mfma_f32_16x16x32_bf16 v[88:91], v[176:179], v[200:203], v[88:91]
    v_mfma_f32_16x16x32_bf16 v[92:95], v[176:179], v[204:207], v[92:95]
    s_waitcnt lgkmcnt(11)
    v_mfma_f32_16x16x32_bf16 v[96:99], v[180:183], v[192:195], v[96:99]
    ds_read_b64_tr_b16 v[220:221], v13 offset:8192
    ds_read_b64_tr_b16 v[222:223], v13 offset:9216
    v_mfma_f32_16x16x32_bf16 v[100:103], v[180:183], v[196:199], v[100:103]
    ds_read_b128 v[172:175], v9 offset:4096
    v_mfma_f32_16x16x32_bf16 v[104:107], v[180:183], v[200:203], v[104:107]
    v_mfma_f32_16x16x32_bf16 v[108:111], v[180:183], v[204:207], v[108:111]
    s_waitcnt lgkmcnt(13)
    v_mfma_f32_16x16x32_bf16 v[112:115], v[184:187], v[192:195], v[112:115]
    ds_read_b128 v[176:179], v9 offset:6144
    v_mfma_f32_16x16x32_bf16 v[116:119], v[184:187], v[196:199], v[116:119]
    v_mfma_f32_16x16x32_bf16 v[120:123], v[184:187], v[200:203], v[120:123]
    v_mfma_f32_16x16x32_bf16 v[124:127], v[184:187], v[204:207], v[124:127]
    s_waitcnt lgkmcnt(13)
    v_mfma_f32_16x16x32_bf16 v[128:131], v[188:191], v[192:195], v[128:131]
    ds_read_b128 v[180:183], v9 offset:8192
    v_mfma_f32_16x16x32_bf16 v[132:135], v[188:191], v[196:199], v[132:135]
    v_mfma_f32_16x16x32_bf16 v[136:139], v[188:191], v[200:203], v[136:139]
    v_mfma_f32_16x16x32_bf16 v[140:143], v[188:191], v[204:207], v[140:143]
    s_waitcnt lgkmcnt(11)
    v_mfma_f32_16x16x32_bf16 v[144:147], v[160:163], v[192:195], v[144:147]
    ds_read_b128 v[184:187], v9 offset:10240
    v_mfma_f32_16x16x32_bf16 v[148:151], v[160:163], v[196:199], v[148:151]
    v_mfma_f32_16x16x32_bf16 v[152:155], v[160:163], v[200:203], v[152:155]
    v_mfma_f32_16x16x32_bf16 v[156:159], v[160:163], v[204:207], v[156:159]
    s_waitcnt lgkmcnt(4)
    v_mfma_f32_16x16x32_bf16 v[16:19], v[164:167], v[208:211], v[16:19]
    ds_read_b128 v[188:191], v9 offset:12288
    v_mfma_f32_16x16x32_bf16 v[20:23], v[164:167], v[212:215], v[20:23]
    ds_read_b128 v[160:163], v9 offset:14336
    v_mfma_f32_16x16x32_bf16 v[24:27], v[164:167], v[216:219], v[24:27]
    v_mfma_f32_16x16x32_bf16 v[28:31], v[164:167], v[220:223], v[28:31]
    v_mfma_f32_16x16x32_bf16 v[32:35], v[168:171], v[208:211], v[32:35]
    ds_read_b128 v[164:167], v9 offset:16384
    v_mfma_f32_16x16x32_bf16 v[36:39], v[168:171], v[212:215], v[36:39]
    v_mfma_f32_16x16x32_bf16 v[40:43], v[168:171], v[216:219], v[40:43]
    v_mfma_f32_16x16x32_bf16 v[44:47], v[168:171], v[220:223], v[44:47]
    s_waitcnt lgkmcnt(6)
    v_mfma_f32_16x16x32_bf16 v[48:51], v[172:175], v[208:211], v[48:51]
    v_mfma_f32_16x16x32_bf16 v[52:55], v[172:175], v[212:215], v[52:55]
    v_mfma_f32_16x16x32_bf16 v[56:59], v[172:175], v[216:219], v[56:59]
    v_mfma_f32_16x16x32_bf16 v[60:63], v[172:175], v[220:223], v[60:63]
    s_waitcnt lgkmcnt(5)
    v_mfma_f32_16x16x32_bf16 v[64:67], v[176:179], v[208:211], v[64:67]
    v_mfma_f32_16x16x32_bf16 v[68:71], v[176:179], v[212:215], v[68:71]
    v_mfma_f32_16x16x32_bf16 v[72:75], v[176:179], v[216:219], v[72:75]
    v_mfma_f32_16x16x32_bf16 v[76:79], v[176:179], v[220:223], v[76:79]
    s_waitcnt lgkmcnt(4)
    v_mfma_f32_16x16x32_bf16 v[80:83], v[180:183], v[208:211], v[80:83]
    v_mfma_f32_16x16x32_bf16 v[84:87], v[180:183], v[212:215], v[84:87]
    v_mfma_f32_16x16x32_bf16 v[88:91], v[180:183], v[216:219], v[88:91]
    v_mfma_f32_16x16x32_bf16 v[92:95], v[180:183], v[220:223], v[92:95]
    s_waitcnt lgkmcnt(0)
    s_barrier
    v_add_u32 v8, 53248, v8
    v_add_u32 v9, 53248, v9
    v_add_u32 v10, 53248, v10
    v_add_u32 v11, 53248, v11
    v_add_u32 v12, 53248, v12
    v_add_u32 v13, 53248, v13
    v_mfma_f32_16x16x32_bf16 v[96:99], v[184:187], v[208:211], v[96:99]
    ds_read_b64_tr_b16 v[192:193], v10 offset:0
    ds_read_b64_tr_b16 v[194:195], v10 offset:1024
    v_mfma_f32_16x16x32_bf16 v[100:103], v[184:187], v[212:215], v[100:103]
    ds_read_b64_tr_b16 v[196:197], v11 offset:0
    ds_read_b64_tr_b16 v[198:199], v11 offset:1024
    v_mfma_f32_16x16x32_bf16 v[104:107], v[184:187], v[216:219], v[104:107]
    ds_read_b128 v[168:171], v8 offset:0
    v_mfma_f32_16x16x32_bf16 v[108:111], v[184:187], v[220:223], v[108:111]
    ds_read_b128 v[172:175], v8 offset:2048
    v_mfma_f32_16x16x32_bf16 v[112:115], v[188:191], v[208:211], v[112:115]
    ds_read_b64_tr_b16 v[200:201], v12 offset:0
    ds_read_b64_tr_b16 v[202:203], v12 offset:1024
    v_mfma_f32_16x16x32_bf16 v[116:119], v[188:191], v[212:215], v[116:119]
    ds_read_b64_tr_b16 v[204:205], v13 offset:0
    ds_read_b64_tr_b16 v[206:207], v13 offset:1024
    v_mfma_f32_16x16x32_bf16 v[120:123], v[188:191], v[216:219], v[120:123]
    ds_read_b128 v[176:179], v8 offset:4096
    v_mfma_f32_16x16x32_bf16 v[124:127], v[188:191], v[220:223], v[124:127]
    ds_read_b128 v[180:183], v8 offset:6144
    v_mfma_f32_16x16x32_bf16 v[128:131], v[160:163], v[208:211], v[128:131]
    ds_read_b128 v[184:187], v8 offset:8192
    v_mfma_f32_16x16x32_bf16 v[132:135], v[160:163], v[212:215], v[132:135]
    ds_read_b128 v[188:191], v8 offset:10240
    v_mfma_f32_16x16x32_bf16 v[136:139], v[160:163], v[216:219], v[136:139]
    v_mfma_f32_16x16x32_bf16 v[140:143], v[160:163], v[220:223], v[140:143]
    v_mfma_f32_16x16x32_bf16 v[144:147], v[164:167], v[208:211], v[144:147]
    ds_read_b128 v[160:163], v8 offset:12288
    v_mfma_f32_16x16x32_bf16 v[148:151], v[164:167], v[212:215], v[148:151]
    v_mfma_f32_16x16x32_bf16 v[152:155], v[164:167], v[216:219], v[152:155]
    v_mfma_f32_16x16x32_bf16 v[156:159], v[164:167], v[220:223], v[156:159]
    s_waitcnt lgkmcnt(5)
    v_mfma_f32_16x16x32_bf16 v[16:19], v[168:171], v[192:195], v[16:19]
    v_mfma_f32_16x16x32_bf16 v[20:23], v[168:171], v[196:199], v[20:23]
    v_mfma_f32_16x16x32_bf16 v[24:27], v[168:171], v[200:203], v[24:27]
    v_mfma_f32_16x16x32_bf16 v[28:31], v[168:171], v[204:207], v[28:31]
    v_mfma_f32_16x16x32_bf16 v[32:35], v[172:175], v[192:195], v[32:35]
    ds_read_b128 v[164:167], v8 offset:14336
    v_mfma_f32_16x16x32_bf16 v[36:39], v[172:175], v[196:199], v[36:39]
    v_mfma_f32_16x16x32_bf16 v[40:43], v[172:175], v[200:203], v[40:43]
    v_mfma_f32_16x16x32_bf16 v[44:47], v[172:175], v[204:207], v[44:47]
    s_waitcnt lgkmcnt(5)
    v_mfma_f32_16x16x32_bf16 v[48:51], v[176:179], v[192:195], v[48:51]
    ds_read_b64_tr_b16 v[208:209], v10 offset:8192
    ds_read_b64_tr_b16 v[210:211], v10 offset:9216
    v_mfma_f32_16x16x32_bf16 v[52:55], v[176:179], v[196:199], v[52:55]
    ds_read_b128 v[168:171], v8 offset:16384
    v_mfma_f32_16x16x32_bf16 v[56:59], v[176:179], v[200:203], v[56:59]
    v_mfma_f32_16x16x32_bf16 v[60:63], v[176:179], v[204:207], v[60:63]
    s_waitcnt lgkmcnt(7)
    v_mfma_f32_16x16x32_bf16 v[64:67], v[180:183], v[192:195], v[64:67]
    ds_read_b64_tr_b16 v[212:213], v11 offset:8192
    ds_read_b64_tr_b16 v[214:215], v11 offset:9216
    v_mfma_f32_16x16x32_bf16 v[68:71], v[180:183], v[196:199], v[68:71]
    ds_read_b128 v[172:175], v9 offset:0
    v_mfma_f32_16x16x32_bf16 v[72:75], v[180:183], v[200:203], v[72:75]
    v_mfma_f32_16x16x32_bf16 v[76:79], v[180:183], v[204:207], v[76:79]
    s_waitcnt lgkmcnt(9)
    v_mfma_f32_16x16x32_bf16 v[80:83], v[184:187], v[192:195], v[80:83]
    ds_read_b64_tr_b16 v[216:217], v12 offset:8192
    ds_read_b64_tr_b16 v[218:219], v12 offset:9216
    v_mfma_f32_16x16x32_bf16 v[84:87], v[184:187], v[196:199], v[84:87]
    ds_read_b128 v[176:179], v9 offset:2048
    v_mfma_f32_16x16x32_bf16 v[88:91], v[184:187], v[200:203], v[88:91]
    v_mfma_f32_16x16x32_bf16 v[92:95], v[184:187], v[204:207], v[92:95]
    s_waitcnt lgkmcnt(11)
    v_mfma_f32_16x16x32_bf16 v[96:99], v[188:191], v[192:195], v[96:99]
    ds_read_b64_tr_b16 v[220:221], v13 offset:8192
    ds_read_b64_tr_b16 v[222:223], v13 offset:9216
    v_mfma_f32_16x16x32_bf16 v[100:103], v[188:191], v[196:199], v[100:103]
    ds_read_b128 v[180:183], v9 offset:4096
    v_mfma_f32_16x16x32_bf16 v[104:107], v[188:191], v[200:203], v[104:107]
    v_mfma_f32_16x16x32_bf16 v[108:111], v[188:191], v[204:207], v[108:111]
    s_waitcnt lgkmcnt(13)
    v_mfma_f32_16x16x32_bf16 v[112:115], v[160:163], v[192:195], v[112:115]
    ds_read_b128 v[184:187], v9 offset:6144
    v_mfma_f32_16x16x32_bf16 v[116:119], v[160:163], v[196:199], v[116:119]
    v_mfma_f32_16x16x32_bf16 v[120:123], v[160:163], v[200:203], v[120:123]
    v_mfma_f32_16x16x32_bf16 v[124:127], v[160:163], v[204:207], v[124:127]
    s_waitcnt lgkmcnt(13)
    v_mfma_f32_16x16x32_bf16 v[128:131], v[164:167], v[192:195], v[128:131]
    ds_read_b128 v[188:191], v9 offset:8192
    v_mfma_f32_16x16x32_bf16 v[132:135], v[164:167], v[196:199], v[132:135]
    v_mfma_f32_16x16x32_bf16 v[136:139], v[164:167], v[200:203], v[136:139]
    v_mfma_f32_16x16x32_bf16 v[140:143], v[164:167], v[204:207], v[140:143]
    s_waitcnt lgkmcnt(11)
    v_mfma_f32_16x16x32_bf16 v[144:147], v[168:171], v[192:195], v[144:147]
    ds_read_b128 v[160:163], v9 offset:10240
    v_mfma_f32_16x16x32_bf16 v[148:151], v[168:171], v[196:199], v[148:151]
    v_mfma_f32_16x16x32_bf16 v[152:155], v[168:171], v[200:203], v[152:155]
    v_mfma_f32_16x16x32_bf16 v[156:159], v[168:171], v[204:207], v[156:159]
    s_waitcnt lgkmcnt(4)
    v_mfma_f32_16x16x32_bf16 v[16:19], v[172:175], v[208:211], v[16:19]
    ds_read_b128 v[164:167], v9 offset:12288
    v_mfma_f32_16x16x32_bf16 v[20:23], v[172:175], v[212:215], v[20:23]
    ds_read_b128 v[168:171], v9 offset:14336
    v_mfma_f32_16x16x32_bf16 v[24:27], v[172:175], v[216:219], v[24:27]
    v_mfma_f32_16x16x32_bf16 v[28:31], v[172:175], v[220:223], v[28:31]
    v_mfma_f32_16x16x32_bf16 v[32:35], v[176:179], v[208:211], v[32:35]
    ds_read_b128 v[172:175], v9 offset:16384
    v_mfma_f32_16x16x32_bf16 v[36:39], v[176:179], v[212:215], v[36:39]
    v_mfma_f32_16x16x32_bf16 v[40:43], v[176:179], v[216:219], v[40:43]
    v_mfma_f32_16x16x32_bf16 v[44:47], v[176:179], v[220:223], v[44:47]
    s_waitcnt lgkmcnt(6)
    v_mfma_f32_16x16x32_bf16 v[48:51], v[180:183], v[208:211], v[48:51]
    v_mfma_f32_16x16x32_bf16 v[52:55], v[180:183], v[212:215], v[52:55]
    v_mfma_f32_16x16x32_bf16 v[56:59], v[180:183], v[216:219], v[56:59]
    v_mfma_f32_16x16x32_bf16 v[60:63], v[180:183], v[220:223], v[60:63]
    s_waitcnt lgkmcnt(5)
    v_mfma_f32_16x16x32_bf16 v[64:67], v[184:187], v[208:211], v[64:67]
    v_mfma_f32_16x16x32_bf16 v[68:71], v[184:187], v[212:215], v[68:71]
    v_mfma_f32_16x16x32_bf16 v[72:75], v[184:187], v[216:219], v[72:75]
    v_mfma_f32_16x16x32_bf16 v[76:79], v[184:187], v[220:223], v[76:79]
    s_waitcnt lgkmcnt(4)
    v_mfma_f32_16x16x32_bf16 v[80:83], v[188:191], v[208:211], v[80:83]
    v_mfma_f32_16x16x32_bf16 v[84:87], v[188:191], v[212:215], v[84:87]
    v_mfma_f32_16x16x32_bf16 v[88:91], v[188:191], v[216:219], v[88:91]
    v_mfma_f32_16x16x32_bf16 v[92:95], v[188:191], v[220:223], v[92:95]
    s_waitcnt lgkmcnt(0)
    s_barrier
    v_subrev_u32 v8, 106496, v8
    v_subrev_u32 v9, 106496, v9
    v_subrev_u32 v10, 106496, v10
    v_subrev_u32 v11, 106496, v11
    v_subrev_u32 v12, 106496, v12
    v_subrev_u32 v13, 106496, v13
    v_mfma_f32_16x16x32_bf16 v[96:99], v[160:163], v[208:211], v[96:99]
    ds_read_b64_tr_b16 v[192:193], v10 offset:0
    ds_read_b64_tr_b16 v[194:195], v10 offset:1024
    v_mfma_f32_16x16x32_bf16 v[100:103], v[160:163], v[212:215], v[100:103]
    ds_read_b64_tr_b16 v[196:197], v11 offset:0
    ds_read_b64_tr_b16 v[198:199], v11 offset:1024
    v_mfma_f32_16x16x32_bf16 v[104:107], v[160:163], v[216:219], v[104:107]
    ds_read_b128 v[176:179], v8 offset:0
    v_mfma_f32_16x16x32_bf16 v[108:111], v[160:163], v[220:223], v[108:111]
    ds_read_b128 v[180:183], v8 offset:2048
    v_mfma_f32_16x16x32_bf16 v[112:115], v[164:167], v[208:211], v[112:115]
    ds_read_b64_tr_b16 v[200:201], v12 offset:0
    ds_read_b64_tr_b16 v[202:203], v12 offset:1024
    v_mfma_f32_16x16x32_bf16 v[116:119], v[164:167], v[212:215], v[116:119]
    ds_read_b64_tr_b16 v[204:205], v13 offset:0
    ds_read_b64_tr_b16 v[206:207], v13 offset:1024
    v_mfma_f32_16x16x32_bf16 v[120:123], v[164:167], v[216:219], v[120:123]
    ds_read_b128 v[184:187], v8 offset:4096
    v_mfma_f32_16x16x32_bf16 v[124:127], v[164:167], v[220:223], v[124:127]
    ds_read_b128 v[188:191], v8 offset:6144
    v_mfma_f32_16x16x32_bf16 v[128:131], v[168:171], v[208:211], v[128:131]
    ds_read_b128 v[160:163], v8 offset:8192
    v_mfma_f32_16x16x32_bf16 v[132:135], v[168:171], v[212:215], v[132:135]
    ds_read_b128 v[164:167], v8 offset:10240
    v_mfma_f32_16x16x32_bf16 v[136:139], v[168:171], v[216:219], v[136:139]
    v_mfma_f32_16x16x32_bf16 v[140:143], v[168:171], v[220:223], v[140:143]
    v_mfma_f32_16x16x32_bf16 v[144:147], v[172:175], v[208:211], v[144:147]
    ds_read_b128 v[168:171], v8 offset:12288
    v_mfma_f32_16x16x32_bf16 v[148:151], v[172:175], v[212:215], v[148:151]
    v_mfma_f32_16x16x32_bf16 v[152:155], v[172:175], v[216:219], v[152:155]
    v_mfma_f32_16x16x32_bf16 v[156:159], v[172:175], v[220:223], v[156:159]
    s_waitcnt lgkmcnt(5)
    v_mfma_f32_16x16x32_bf16 v[16:19], v[176:179], v[192:195], v[16:19]
    v_mfma_f32_16x16x32_bf16 v[20:23], v[176:179], v[196:199], v[20:23]
    v_mfma_f32_16x16x32_bf16 v[24:27], v[176:179], v[200:203], v[24:27]
    v_mfma_f32_16x16x32_bf16 v[28:31], v[176:179], v[204:207], v[28:31]
    v_mfma_f32_16x16x32_bf16 v[32:35], v[180:183], v[192:195], v[32:35]
    ds_read_b128 v[172:175], v8 offset:14336
    v_mfma_f32_16x16x32_bf16 v[36:39], v[180:183], v[196:199], v[36:39]
    v_mfma_f32_16x16x32_bf16 v[40:43], v[180:183], v[200:203], v[40:43]
    v_mfma_f32_16x16x32_bf16 v[44:47], v[180:183], v[204:207], v[44:47]
    s_waitcnt lgkmcnt(5)
    v_mfma_f32_16x16x32_bf16 v[48:51], v[184:187], v[192:195], v[48:51]
    ds_read_b64_tr_b16 v[208:209], v10 offset:8192
    ds_read_b64_tr_b16 v[210:211], v10 offset:9216
    v_mfma_f32_16x16x32_bf16 v[52:55], v[184:187], v[196:199], v[52:55]
    ds_read_b128 v[176:179], v8 offset:16384
    v_mfma_f32_16x16x32_bf16 v[56:59], v[184:187], v[200:203], v[56:59]
    v_mfma_f32_16x16x32_bf16 v[60:63], v[184:187], v[204:207], v[60:63]
    s_waitcnt lgkmcnt(7)
    v_mfma_f32_16x16x32_bf16 v[64:67], v[188:191], v[192:195], v[64:67]
    ds_read_b64_tr_b16 v[212:213], v11 offset:8192
    ds_read_b64_tr_b16 v[214:215], v11 offset:9216
    v_mfma_f32_16x16x32_bf16 v[68:71], v[188:191], v[196:199], v[68:71]
    ds_read_b128 v[180:183], v9 offset:0
    v_mfma_f32_16x16x32_bf16 v[72:75], v[188:191], v[200:203], v[72:75]
    v_mfma_f32_16x16x32_bf16 v[76:79], v[188:191], v[204:207], v[76:79]
    s_waitcnt lgkmcnt(9)
    v_mfma_f32_16x16x32_bf16 v[80:83], v[160:163], v[192:195], v[80:83]
    ds_read_b64_tr_b16 v[216:217], v12 offset:8192
    ds_read_b64_tr_b16 v[218:219], v12 offset:9216
    v_mfma_f32_16x16x32_bf16 v[84:87], v[160:163], v[196:199], v[84:87]
    ds_read_b128 v[184:187], v9 offset:2048
    v_mfma_f32_16x16x32_bf16 v[88:91], v[160:163], v[200:203], v[88:91]
    v_mfma_f32_16x16x32_bf16 v[92:95], v[160:163], v[204:207], v[92:95]
    s_waitcnt lgkmcnt(11)
    v_mfma_f32_16x16x32_bf16 v[96:99], v[164:167], v[192:195], v[96:99]
    ds_read_b64_tr_b16 v[220:221], v13 offset:8192
    ds_read_b64_tr_b16 v[222:223], v13 offset:9216
    v_mfma_f32_16x16x32_bf16 v[100:103], v[164:167], v[196:199], v[100:103]
    ds_read_b128 v[188:191], v9 offset:4096
    v_mfma_f32_16x16x32_bf16 v[104:107], v[164:167], v[200:203], v[104:107]
    v_mfma_f32_16x16x32_bf16 v[108:111], v[164:167], v[204:207], v[108:111]
    s_waitcnt lgkmcnt(13)
    v_mfma_f32_16x16x32_bf16 v[112:115], v[168:171], v[192:195], v[112:115]
    ds_read_b128 v[160:163], v9 offset:6144
    v_mfma_f32_16x16x32_bf16 v[116:119], v[168:171], v[196:199], v[116:119]
    v_mfma_f32_16x16x32_bf16 v[120:123], v[168:171], v[200:203], v[120:123]
    v_mfma_f32_16x16x32_bf16 v[124:127], v[168:171], v[204:207], v[124:127]
    s_waitcnt lgkmcnt(13)
    v_mfma_f32_16x16x32_bf16 v[128:131], v[172:175], v[192:195], v[128:131]
    ds_read_b128 v[164:167], v9 offset:8192
    v_mfma_f32_16x16x32_bf16 v[132:135], v[172:175], v[196:199], v[132:135]
    v_mfma_f32_16x16x32_bf16 v[136:139], v[172:175], v[200:203], v[136:139]
    v_mfma_f32_16x16x32_bf16 v[140:143], v[172:175], v[204:207], v[140:143]
    s_waitcnt lgkmcnt(11)
    v_mfma_f32_16x16x32_bf16 v[144:147], v[176:179], v[192:195], v[144:147]
    ds_read_b128 v[168:171], v9 offset:10240
    v_mfma_f32_16x16x32_bf16 v[148:151], v[176:179], v[196:199], v[148:151]
    v_mfma_f32_16x16x32_bf16 v[152:155], v[176:179], v[200:203], v[152:155]
    v_mfma_f32_16x16x32_bf16 v[156:159], v[176:179], v[204:207], v[156:159]
    s_waitcnt lgkmcnt(4)
    v_mfma_f32_16x16x32_bf16 v[16:19], v[180:183], v[208:211], v[16:19]
    ds_read_b128 v[172:175], v9 offset:12288
    v_mfma_f32_16x16x32_bf16 v[20:23], v[180:183], v[212:215], v[20:23]
    ds_read_b128 v[176:179], v9 offset:14336
    v_mfma_f32_16x16x32_bf16 v[24:27], v[180:183], v[216:219], v[24:27]
    v_mfma_f32_16x16x32_bf16 v[28:31], v[180:183], v[220:223], v[28:31]
    v_mfma_f32_16x16x32_bf16 v[32:35], v[184:187], v[208:211], v[32:35]
    ds_read_b128 v[180:183], v9 offset:16384
    v_mfma_f32_16x16x32_bf16 v[36:39], v[184:187], v[212:215], v[36:39]
    v_mfma_f32_16x16x32_bf16 v[40:43], v[184:187], v[216:219], v[40:43]
    v_mfma_f32_16x16x32_bf16 v[44:47], v[184:187], v[220:223], v[44:47]
    s_waitcnt lgkmcnt(6)
    v_mfma_f32_16x16x32_bf16 v[48:51], v[188:191], v[208:211], v[48:51]
    v_mfma_f32_16x16x32_bf16 v[52:55], v[188:191], v[212:215], v[52:55]
    v_mfma_f32_16x16x32_bf16 v[56:59], v[188:191], v[216:219], v[56:59]
    v_mfma_f32_16x16x32_bf16 v[60:63], v[188:191], v[220:223], v[60:63]
    s_waitcnt lgkmcnt(5)
    v_mfma_f32_16x16x32_bf16 v[64:67], v[160:163], v[208:211], v[64:67]
    v_mfma_f32_16x16x32_bf16 v[68:71], v[160:163], v[212:215], v[68:71]
    v_mfma_f32_16x16x32_bf16 v[72:75], v[160:163], v[216:219], v[72:75]
    v_mfma_f32_16x16x32_bf16 v[76:79], v[160:163], v[220:223], v[76:79]
    s_waitcnt lgkmcnt(4)
    v_mfma_f32_16x16x32_bf16 v[80:83], v[164:167], v[208:211], v[80:83]
    v_mfma_f32_16x16x32_bf16 v[84:87], v[164:167], v[212:215], v[84:87]
    v_mfma_f32_16x16x32_bf16 v[88:91], v[164:167], v[216:219], v[88:91]
    v_mfma_f32_16x16x32_bf16 v[92:95], v[164:167], v[220:223], v[92:95]
    s_waitcnt lgkmcnt(0)
    s_barrier
    v_add_u32 v8, 53248, v8
    v_add_u32 v9, 53248, v9
    v_add_u32 v10, 53248, v10
    v_add_u32 v11, 53248, v11
    v_add_u32 v12, 53248, v12
    v_add_u32 v13, 53248, v13
    v_mfma_f32_16x16x32_bf16 v[96:99], v[168:171], v[208:211], v[96:99]
    ds_read_b64_tr_b16 v[192:193], v10 offset:0
    ds_read_b64_tr_b16 v[194:195], v10 offset:1024
    v_mfma_f32_16x16x32_bf16 v[100:103], v[168:171], v[212:215], v[100:103]
    ds_read_b64_tr_b16 v[196:197], v11 offset:0
    ds_read_b64_tr_b16 v[198:199], v11 offset:1024
    v_mfma_f32_16x16x32_bf16 v[104:107], v[168:171], v[216:219], v[104:107]
    ds_read_b128 v[184:187], v8 offset:0
    v_mfma_f32_16x16x32_bf16 v[108:111], v[168:171], v[220:223], v[108:111]
    ds_read_b128 v[188:191], v8 offset:2048
    v_mfma_f32_16x16x32_bf16 v[112:115], v[172:175], v[208:211], v[112:115]
    ds_read_b64_tr_b16 v[200:201], v12 offset:0
    ds_read_b64_tr_b16 v[202:203], v12 offset:1024
    v_mfma_f32_16x16x32_bf16 v[116:119], v[172:175], v[212:215], v[116:119]
    ds_read_b64_tr_b16 v[204:205], v13 offset:0
    ds_read_b64_tr_b16 v[206:207], v13 offset:1024
    v_mfma_f32_16x16x32_bf16 v[120:123], v[172:175], v[216:219], v[120:123]
    ds_read_b128 v[160:163], v8 offset:4096
    v_mfma_f32_16x16x32_bf16 v[124:127], v[172:175], v[220:223], v[124:127]
    ds_read_b128 v[164:167], v8 offset:6144
    v_mfma_f32_16x16x32_bf16 v[128:131], v[176:179], v[208:211], v[128:131]
    ds_read_b128 v[168:171], v8 offset:8192
    v_mfma_f32_16x16x32_bf16 v[132:135], v[176:179], v[212:215], v[132:135]
    ds_read_b128 v[172:175], v8 offset:10240
    v_mfma_f32_16x16x32_bf16 v[136:139], v[176:179], v[216:219], v[136:139]
    v_mfma_f32_16x16x32_bf16 v[140:143], v[176:179], v[220:223], v[140:143]
    v_mfma_f32_16x16x32_bf16 v[144:147], v[180:183], v[208:211], v[144:147]
    ds_read_b128 v[176:179], v8 offset:12288
    v_mfma_f32_16x16x32_bf16 v[148:151], v[180:183], v[212:215], v[148:151]
    v_mfma_f32_16x16x32_bf16 v[152:155], v[180:183], v[216:219], v[152:155]
    v_mfma_f32_16x16x32_bf16 v[156:159], v[180:183], v[220:223], v[156:159]
    s_waitcnt lgkmcnt(5)
    v_mfma_f32_16x16x32_bf16 v[16:19], v[184:187], v[192:195], v[16:19]
    ds_read_b128 v[180:183], v8 offset:14336
    v_mfma_f32_16x16x32_bf16 v[20:23], v[184:187], v[196:199], v[20:23]
    v_mfma_f32_16x16x32_bf16 v[24:27], v[184:187], v[200:203], v[24:27]
    v_mfma_f32_16x16x32_bf16 v[28:31], v[184:187], v[204:207], v[28:31]
    v_mfma_f32_16x16x32_bf16 v[32:35], v[188:191], v[192:195], v[32:35]
    ds_read_b128 v[184:187], v8 offset:16384
    v_mfma_f32_16x16x32_bf16 v[36:39], v[188:191], v[196:199], v[36:39]
    v_mfma_f32_16x16x32_bf16 v[40:43], v[188:191], v[200:203], v[40:43]
    v_mfma_f32_16x16x32_bf16 v[44:47], v[188:191], v[204:207], v[44:47]
    s_waitcnt lgkmcnt(6)
    v_mfma_f32_16x16x32_bf16 v[48:51], v[160:163], v[192:195], v[48:51]
    ds_read_b64_tr_b16 v[208:209], v10 offset:8192
    ds_read_b64_tr_b16 v[210:211], v10 offset:9216
    v_mfma_f32_16x16x32_bf16 v[52:55], v[160:163], v[196:199], v[52:55]
    ds_read_b128 v[188:191], v9 offset:0
    v_mfma_f32_16x16x32_bf16 v[56:59], v[160:163], v[200:203], v[56:59]
    v_mfma_f32_16x16x32_bf16 v[60:63], v[160:163], v[204:207], v[60:63]
    s_waitcnt lgkmcnt(8)
    v_mfma_f32_16x16x32_bf16 v[64:67], v[164:167], v[192:195], v[64:67]
    ds_read_b64_tr_b16 v[212:213], v11 offset:8192
    ds_read_b64_tr_b16 v[214:215], v11 offset:9216
    v_mfma_f32_16x16x32_bf16 v[68:71], v[164:167], v[196:199], v[68:71]
    ds_read_b128 v[160:163], v9 offset:2048
    v_mfma_f32_16x16x32_bf16 v[72:75], v[164:167], v[200:203], v[72:75]
    v_mfma_f32_16x16x32_bf16 v[76:79], v[164:167], v[204:207], v[76:79]
    s_waitcnt lgkmcnt(10)
    v_mfma_f32_16x16x32_bf16 v[80:83], v[168:171], v[192:195], v[80:83]
    ds_read_b64_tr_b16 v[216:217], v12 offset:8192
    ds_read_b64_tr_b16 v[218:219], v12 offset:9216
    v_mfma_f32_16x16x32_bf16 v[84:87], v[168:171], v[196:199], v[84:87]
    ds_read_b128 v[164:167], v9 offset:4096
    v_mfma_f32_16x16x32_bf16 v[88:91], v[168:171], v[200:203], v[88:91]
    v_mfma_f32_16x16x32_bf16 v[92:95], v[168:171], v[204:207], v[92:95]
    s_waitcnt lgkmcnt(12)
    v_mfma_f32_16x16x32_bf16 v[96:99], v[172:175], v[192:195], v[96:99]
    ds_read_b64_tr_b16 v[220:221], v13 offset:8192
    ds_read_b64_tr_b16 v[222:223], v13 offset:9216
    v_mfma_f32_16x16x32_bf16 v[100:103], v[172:175], v[196:199], v[100:103]
    ds_read_b128 v[168:171], v9 offset:6144
    v_mfma_f32_16x16x32_bf16 v[104:107], v[172:175], v[200:203], v[104:107]
    v_mfma_f32_16x16x32_bf16 v[108:111], v[172:175], v[204:207], v[108:111]
    s_waitcnt lgkmcnt(14)
    v_mfma_f32_16x16x32_bf16 v[112:115], v[176:179], v[192:195], v[112:115]
    ds_read_b128 v[172:175], v9 offset:8192
    v_mfma_f32_16x16x32_bf16 v[116:119], v[176:179], v[196:199], v[116:119]
    v_mfma_f32_16x16x32_bf16 v[120:123], v[176:179], v[200:203], v[120:123]
    v_mfma_f32_16x16x32_bf16 v[124:127], v[176:179], v[204:207], v[124:127]
    s_waitcnt lgkmcnt(14)
    v_mfma_f32_16x16x32_bf16 v[128:131], v[180:183], v[192:195], v[128:131]
    ds_read_b128 v[176:179], v9 offset:10240
    v_mfma_f32_16x16x32_bf16 v[132:135], v[180:183], v[196:199], v[132:135]
    v_mfma_f32_16x16x32_bf16 v[136:139], v[180:183], v[200:203], v[136:139]
    v_mfma_f32_16x16x32_bf16 v[140:143], v[180:183], v[204:207], v[140:143]
    s_waitcnt lgkmcnt(14)
    v_mfma_f32_16x16x32_bf16 v[144:147], v[184:187], v[192:195], v[144:147]
    ds_read_b128 v[180:183], v9 offset:12288
    v_mfma_f32_16x16x32_bf16 v[148:151], v[184:187], v[196:199], v[148:151]
    v_mfma_f32_16x16x32_bf16 v[152:155], v[184:187], v[200:203], v[152:155]
    v_mfma_f32_16x16x32_bf16 v[156:159], v[184:187], v[204:207], v[156:159]
    s_waitcnt lgkmcnt(4)
    v_mfma_f32_16x16x32_bf16 v[16:19], v[188:191], v[208:211], v[16:19]
    ds_read_b128 v[184:187], v9 offset:14336
    v_mfma_f32_16x16x32_bf16 v[20:23], v[188:191], v[212:215], v[20:23]
    v_mfma_f32_16x16x32_bf16 v[24:27], v[188:191], v[216:219], v[24:27]
    v_mfma_f32_16x16x32_bf16 v[28:31], v[188:191], v[220:223], v[28:31]
    v_mfma_f32_16x16x32_bf16 v[32:35], v[160:163], v[208:211], v[32:35]
    ds_read_b128 v[188:191], v9 offset:16384
    v_mfma_f32_16x16x32_bf16 v[36:39], v[160:163], v[212:215], v[36:39]
    v_mfma_f32_16x16x32_bf16 v[40:43], v[160:163], v[216:219], v[40:43]
    v_mfma_f32_16x16x32_bf16 v[44:47], v[160:163], v[220:223], v[44:47]
    v_mfma_f32_16x16x32_bf16 v[48:51], v[164:167], v[208:211], v[48:51]
    v_mfma_f32_16x16x32_bf16 v[52:55], v[164:167], v[212:215], v[52:55]
    v_mfma_f32_16x16x32_bf16 v[56:59], v[164:167], v[216:219], v[56:59]
    v_mfma_f32_16x16x32_bf16 v[60:63], v[164:167], v[220:223], v[60:63]
    s_waitcnt lgkmcnt(5)
    v_mfma_f32_16x16x32_bf16 v[64:67], v[168:171], v[208:211], v[64:67]
    v_mfma_f32_16x16x32_bf16 v[68:71], v[168:171], v[212:215], v[68:71]
    v_mfma_f32_16x16x32_bf16 v[72:75], v[168:171], v[216:219], v[72:75]
    v_mfma_f32_16x16x32_bf16 v[76:79], v[168:171], v[220:223], v[76:79]
    s_waitcnt lgkmcnt(4)
    v_mfma_f32_16x16x32_bf16 v[80:83], v[172:175], v[208:211], v[80:83]
    v_mfma_f32_16x16x32_bf16 v[84:87], v[172:175], v[212:215], v[84:87]
    v_mfma_f32_16x16x32_bf16 v[88:91], v[172:175], v[216:219], v[88:91]
    v_mfma_f32_16x16x32_bf16 v[92:95], v[172:175], v[220:223], v[92:95]
    s_waitcnt lgkmcnt(3)
    v_mfma_f32_16x16x32_bf16 v[96:99], v[176:179], v[208:211], v[96:99]
    v_mfma_f32_16x16x32_bf16 v[100:103], v[176:179], v[212:215], v[100:103]
    v_mfma_f32_16x16x32_bf16 v[104:107], v[176:179], v[216:219], v[104:107]
    v_mfma_f32_16x16x32_bf16 v[108:111], v[176:179], v[220:223], v[108:111]
    s_waitcnt lgkmcnt(2)
    v_mfma_f32_16x16x32_bf16 v[112:115], v[180:183], v[208:211], v[112:115]
    v_mfma_f32_16x16x32_bf16 v[116:119], v[180:183], v[212:215], v[116:119]
    v_mfma_f32_16x16x32_bf16 v[120:123], v[180:183], v[216:219], v[120:123]
    v_mfma_f32_16x16x32_bf16 v[124:127], v[180:183], v[220:223], v[124:127]
    s_waitcnt lgkmcnt(1)
    v_mfma_f32_16x16x32_bf16 v[128:131], v[184:187], v[208:211], v[128:131]
    v_mfma_f32_16x16x32_bf16 v[132:135], v[184:187], v[212:215], v[132:135]
    v_mfma_f32_16x16x32_bf16 v[136:139], v[184:187], v[216:219], v[136:139]
    v_mfma_f32_16x16x32_bf16 v[140:143], v[184:187], v[220:223], v[140:143]
    s_waitcnt lgkmcnt(0)
    v_mfma_f32_16x16x32_bf16 v[144:147], v[188:191], v[208:211], v[144:147]
    v_mfma_f32_16x16x32_bf16 v[148:151], v[188:191], v[212:215], v[148:151]
    v_mfma_f32_16x16x32_bf16 v[152:155], v[188:191], v[216:219], v[152:155]
    v_mfma_f32_16x16x32_bf16 v[156:159], v[188:191], v[220:223], v[156:159]
    s_nop 3
    v_pk_mul_f32 v[24:25], v[24:25], s[76:77]
    v_pk_mul_f32 v[26:27], v[26:27], s[76:77]
    v_exp_f32 v24, v24
    v_exp_f32 v25, v25
    v_exp_f32 v26, v26
    v_exp_f32 v27, v27
    v_pk_add_f32 v[24:25], v[24:25], 1.0 op_sel_hi:[1,0]
    v_pk_add_f32 v[26:27], v[26:27], 1.0 op_sel_hi:[1,0]
    v_rcp_f32 v24, v24
    v_rcp_f32 v25, v25
    v_rcp_f32 v26, v26
    v_rcp_f32 v27, v27
    v_pk_mul_f32 v[24:25], v[24:25], v[16:17]
    v_pk_mul_f32 v[26:27], v[26:27], v[18:19]
    v_cvt_pk_bf16_f32 v16, v24, v25
    v_cvt_pk_bf16_f32 v17, v26, v27
    ds_write_b64 v14, v[16:17] offset:0
    v_pk_mul_f32 v[40:41], v[40:41], s[76:77]
    v_pk_mul_f32 v[42:43], v[42:43], s[76:77]
    v_exp_f32 v40, v40
    v_exp_f32 v41, v41
    v_exp_f32 v42, v42
    v_exp_f32 v43, v43
    v_pk_add_f32 v[40:41], v[40:41], 1.0 op_sel_hi:[1,0]
    v_pk_add_f32 v[42:43], v[42:43], 1.0 op_sel_hi:[1,0]
    v_rcp_f32 v40, v40
    v_rcp_f32 v41, v41
    v_rcp_f32 v42, v42
    v_rcp_f32 v43, v43
    v_pk_mul_f32 v[40:41], v[40:41], v[32:33]
    v_pk_mul_f32 v[42:43], v[42:43], v[34:35]
    v_cvt_pk_bf16_f32 v32, v40, v41
    v_cvt_pk_bf16_f32 v33, v42, v43
    ds_write_b64 v14, v[32:33] offset:32
    v_pk_mul_f32 v[56:57], v[56:57], s[76:77]
    v_pk_mul_f32 v[58:59], v[58:59], s[76:77]
    v_exp_f32 v56, v56
    v_exp_f32 v57, v57
    v_exp_f32 v58, v58
    v_exp_f32 v59, v59
    v_pk_add_f32 v[56:57], v[56:57], 1.0 op_sel_hi:[1,0]
    v_pk_add_f32 v[58:59], v[58:59], 1.0 op_sel_hi:[1,0]
    v_rcp_f32 v56, v56
    v_rcp_f32 v57, v57
    v_rcp_f32 v58, v58
    v_rcp_f32 v59, v59
    v_pk_mul_f32 v[56:57], v[56:57], v[48:49]
    v_pk_mul_f32 v[58:59], v[58:59], v[50:51]
    v_cvt_pk_bf16_f32 v48, v56, v57
    v_cvt_pk_bf16_f32 v49, v58, v59
    ds_write_b64 v14, v[48:49] offset:64
    v_pk_mul_f32 v[72:73], v[72:73], s[76:77]
    v_pk_mul_f32 v[74:75], v[74:75], s[76:77]
    v_exp_f32 v72, v72
    v_exp_f32 v73, v73
    v_exp_f32 v74, v74
    v_exp_f32 v75, v75
    v_pk_add_f32 v[72:73], v[72:73], 1.0 op_sel_hi:[1,0]
    v_pk_add_f32 v[74:75], v[74:75], 1.0 op_sel_hi:[1,0]
    v_rcp_f32 v72, v72
    v_rcp_f32 v73, v73
    v_rcp_f32 v74, v74
    v_rcp_f32 v75, v75
    v_pk_mul_f32 v[72:73], v[72:73], v[64:65]
    v_pk_mul_f32 v[74:75], v[74:75], v[66:67]
    v_cvt_pk_bf16_f32 v64, v72, v73
    v_cvt_pk_bf16_f32 v65, v74, v75
    ds_write_b64 v14, v[64:65] offset:96
    v_pk_mul_f32 v[88:89], v[88:89], s[76:77]
    v_pk_mul_f32 v[90:91], v[90:91], s[76:77]
    v_exp_f32 v88, v88
    v_exp_f32 v89, v89
    v_exp_f32 v90, v90
    v_exp_f32 v91, v91
    v_pk_add_f32 v[88:89], v[88:89], 1.0 op_sel_hi:[1,0]
    v_pk_add_f32 v[90:91], v[90:91], 1.0 op_sel_hi:[1,0]
    v_rcp_f32 v88, v88
    v_rcp_f32 v89, v89
    v_rcp_f32 v90, v90
    v_rcp_f32 v91, v91
    v_pk_mul_f32 v[88:89], v[88:89], v[80:81]
    v_pk_mul_f32 v[90:91], v[90:91], v[82:83]
    v_cvt_pk_bf16_f32 v80, v88, v89
    v_cvt_pk_bf16_f32 v81, v90, v91
    ds_write_b64 v14, v[80:81] offset:128
    v_pk_mul_f32 v[104:105], v[104:105], s[76:77]
    v_pk_mul_f32 v[106:107], v[106:107], s[76:77]
    v_exp_f32 v104, v104
    v_exp_f32 v105, v105
    v_exp_f32 v106, v106
    v_exp_f32 v107, v107
    v_pk_add_f32 v[104:105], v[104:105], 1.0 op_sel_hi:[1,0]
    v_pk_add_f32 v[106:107], v[106:107], 1.0 op_sel_hi:[1,0]
    v_rcp_f32 v104, v104
    v_rcp_f32 v105, v105
    v_rcp_f32 v106, v106
    v_rcp_f32 v107, v107
    v_pk_mul_f32 v[104:105], v[104:105], v[96:97]
    v_pk_mul_f32 v[106:107], v[106:107], v[98:99]
    v_cvt_pk_bf16_f32 v96, v104, v105
    v_cvt_pk_bf16_f32 v97, v106, v107
    ds_write_b64 v14, v[96:97] offset:160
    v_pk_mul_f32 v[120:121], v[120:121], s[76:77]
    v_pk_mul_f32 v[122:123], v[122:123], s[76:77]
    v_exp_f32 v120, v120
    v_exp_f32 v121, v121
    v_exp_f32 v122, v122
    v_exp_f32 v123, v123
    v_pk_add_f32 v[120:121], v[120:121], 1.0 op_sel_hi:[1,0]
    v_pk_add_f32 v[122:123], v[122:123], 1.0 op_sel_hi:[1,0]
    v_rcp_f32 v120, v120
    v_rcp_f32 v121, v121
    v_rcp_f32 v122, v122
    v_rcp_f32 v123, v123
    v_pk_mul_f32 v[120:121], v[120:121], v[112:113]
    v_pk_mul_f32 v[122:123], v[122:123], v[114:115]
    v_cvt_pk_bf16_f32 v112, v120, v121
    v_cvt_pk_bf16_f32 v113, v122, v123
    ds_write_b64 v14, v[112:113] offset:192
    v_pk_mul_f32 v[136:137], v[136:137], s[76:77]
    v_pk_mul_f32 v[138:139], v[138:139], s[76:77]
    v_exp_f32 v136, v136
    v_exp_f32 v137, v137
    v_exp_f32 v138, v138
    v_exp_f32 v139, v139
    v_pk_add_f32 v[136:137], v[136:137], 1.0 op_sel_hi:[1,0]
    v_pk_add_f32 v[138:139], v[138:139], 1.0 op_sel_hi:[1,0]
    v_rcp_f32 v136, v136
    v_rcp_f32 v137, v137
    v_rcp_f32 v138, v138
    v_rcp_f32 v139, v139
    v_pk_mul_f32 v[136:137], v[136:137], v[128:129]
    v_pk_mul_f32 v[138:139], v[138:139], v[130:131]
    v_cvt_pk_bf16_f32 v128, v136, v137
    v_cvt_pk_bf16_f32 v129, v138, v139
    ds_write_b64 v14, v[128:129] offset:224
    v_pk_mul_f32 v[152:153], v[152:153], s[76:77]
    v_pk_mul_f32 v[154:155], v[154:155], s[76:77]
    v_exp_f32 v152, v152
    v_exp_f32 v153, v153
    v_exp_f32 v154, v154
    v_exp_f32 v155, v155
    v_pk_add_f32 v[152:153], v[152:153], 1.0 op_sel_hi:[1,0]
    v_pk_add_f32 v[154:155], v[154:155], 1.0 op_sel_hi:[1,0]
    v_rcp_f32 v152, v152
    v_rcp_f32 v153, v153
    v_rcp_f32 v154, v154
    v_rcp_f32 v155, v155
    v_pk_mul_f32 v[152:153], v[152:153], v[144:145]
    v_pk_mul_f32 v[154:155], v[154:155], v[146:147]
    v_cvt_pk_bf16_f32 v144, v152, v153
    v_cvt_pk_bf16_f32 v145, v154, v155
    ds_write_b64 v14, v[144:145] offset:256
    s_waitcnt lgkmcnt(0)
    s_barrier
    ds_read_b64 v[250:251], v249
    s_add_u32 m0, s74, 49152
    s_add_u32 s75, s19, 0
    s_and_b32 s75, s75, 7
    s_lshl_b32 s75, s75, 16
    s_add_u32 s75, s75, 32768
    buffer_load_dwordx4 v3, s[28:31], s75 offen lds
    s_add_u32 m0, s74, 53248
    s_add_u32 s75, s19, 0
    s_and_b32 s75, s75, 7
    s_lshl_b32 s75, s75, 16
    s_add_u32 s75, s75, 49152
    buffer_load_dwordx4 v3, s[28:31], s75 offen lds
    s_add_u32 m0, s74, 57344
    s_add_u32 s75, s19, 1
    s_and_b32 s75, s75, 7
    s_lshl_b32 s75, s75, 16
    s_add_u32 s75, s75, 32768
    buffer_load_dwordx4 v3, s[28:31], s75 offen lds
    s_add_u32 m0, s74, 61440
    s_add_u32 s75, s19, 1
    s_and_b32 s75, s75, 7
    s_lshl_b32 s75, s75, 16
    s_add_u32 s75, s75, 49152
    buffer_load_dwordx4 v3, s[28:31], s75 offen lds
    s_add_u32 m0, s74, 65536
    s_add_u32 s75, s19, 2
    s_and_b32 s75, s75, 7
    s_lshl_b32 s75, s75, 16
    s_add_u32 s75, s75, 32768
    buffer_load_dwordx4 v3, s[28:31], s75 offen lds
    s_add_u32 m0, s74, 69632
    s_add_u32 s75, s19, 2
    s_and_b32 s75, s75, 7
    s_lshl_b32 s75, s75, 16
    s_add_u32 s75, s75, 49152
    buffer_load_dwordx4 v3, s[28:31], s75 offen lds
    s_add_u32 m0, s74, 73728
    s_add_u32 s75, s19, 3
    s_and_b32 s75, s75, 7
    s_lshl_b32 s75, s75, 16
    s_add_u32 s75, s75, 32768
    buffer_load_dwordx4 v3, s[28:31], s75 offen lds
    s_add_u32 m0, s74, 77824
    s_add_u32 s75, s19, 3
    s_and_b32 s75, s75, 7
    s_lshl_b32 s75, s75, 16
    s_add_u32 s75, s75, 49152
    buffer_load_dwordx4 v3, s[28:31], s75 offen lds
    s_add_u32 m0, s74, 81920
    s_add_u32 s75, s19, 4
    s_and_b32 s75, s75, 7
    s_lshl_b32 s75, s75, 16
    s_add_u32 s75, s75, 32768
    buffer_load_dwordx4 v3, s[28:31], s75 offen lds
    s_add_u32 m0, s74, 86016
    s_add_u32 s75, s19, 4
    s_and_b32 s75, s75, 7
    s_lshl_b32 s75, s75, 16
    s_add_u32 s75, s75, 49152
    buffer_load_dwordx4 v3, s[28:31], s75 offen lds
    s_add_u32 m0, s74, 90112
    s_add_u32 s75, s19, 5
    s_and_b32 s75, s75, 7
    s_lshl_b32 s75, s75, 16
    s_add_u32 s75, s75, 32768
    buffer_load_dwordx4 v3, s[28:31], s75 offen lds
    s_add_u32 m0, s74, 94208
    s_add_u32 s75, s19, 5
    s_and_b32 s75, s75, 7
    s_lshl_b32 s75, s75, 16
    s_add_u32 s75, s75, 49152
    buffer_load_dwordx4 v3, s[28:31], s75 offen lds
    s_add_u32 m0, s74, 98304
    s_add_u32 s75, s19, 6
    s_and_b32 s75, s75, 7
    s_lshl_b32 s75, s75, 16
    s_add_u32 s75, s75, 32768
    buffer_load_dwordx4 v3, s[28:31], s75 offen lds
    s_add_u32 m0, s74, 102400
    s_add_u32 s75, s19, 6
    s_and_b32 s75, s75, 7
    s_lshl_b32 s75, s75, 16
    s_add_u32 s75, s75, 49152
    buffer_load_dwordx4 v3, s[28:31], s75 offen lds
    v_pk_mul_f32 v[28:29], v[28:29], s[76:77]
    v_pk_mul_f32 v[30:31], v[30:31], s[76:77]
    v_exp_f32 v28, v28
    v_exp_f32 v29, v29
    v_exp_f32 v30, v30
    v_exp_f32 v31, v31
    v_pk_add_f32 v[28:29], v[28:29], 1.0 op_sel_hi:[1,0]
    v_pk_add_f32 v[30:31], v[30:31], 1.0 op_sel_hi:[1,0]
    v_rcp_f32 v28, v28
    v_rcp_f32 v29, v29
    v_rcp_f32 v30, v30
    v_rcp_f32 v31, v31
    v_pk_mul_f32 v[28:29], v[28:29], v[20:21]
    v_pk_mul_f32 v[30:31], v[30:31], v[22:23]
    v_cvt_pk_bf16_f32 v20, v28, v29
    v_cvt_pk_bf16_f32 v21, v30, v31
    v_pk_mul_f32 v[44:45], v[44:45], s[76:77]
    v_pk_mul_f32 v[46:47], v[46:47], s[76:77]
    v_exp_f32 v44, v44
    v_exp_f32 v45, v45
    v_exp_f32 v46, v46
    v_exp_f32 v47, v47
    v_pk_add_f32 v[44:45], v[44:45], 1.0 op_sel_hi:[1,0]
    v_pk_add_f32 v[46:47], v[46:47], 1.0 op_sel_hi:[1,0]
    v_rcp_f32 v44, v44
    v_rcp_f32 v45, v45
    v_rcp_f32 v46, v46
    v_rcp_f32 v47, v47
    v_pk_mul_f32 v[44:45], v[44:45], v[36:37]
    v_pk_mul_f32 v[46:47], v[46:47], v[38:39]
    v_cvt_pk_bf16_f32 v36, v44, v45
    v_cvt_pk_bf16_f32 v37, v46, v47
    v_pk_mul_f32 v[60:61], v[60:61], s[76:77]
    v_pk_mul_f32 v[62:63], v[62:63], s[76:77]
    v_exp_f32 v60, v60
    v_exp_f32 v61, v61
    v_exp_f32 v62, v62
    v_exp_f32 v63, v63
    v_pk_add_f32 v[60:61], v[60:61], 1.0 op_sel_hi:[1,0]
    v_pk_add_f32 v[62:63], v[62:63], 1.0 op_sel_hi:[1,0]
    v_rcp_f32 v60, v60
    v_rcp_f32 v61, v61
    v_rcp_f32 v62, v62
    v_rcp_f32 v63, v63
    v_pk_mul_f32 v[60:61], v[60:61], v[52:53]
    v_pk_mul_f32 v[62:63], v[62:63], v[54:55]
    v_cvt_pk_bf16_f32 v52, v60, v61
    v_cvt_pk_bf16_f32 v53, v62, v63
    v_pk_mul_f32 v[76:77], v[76:77], s[76:77]
    v_pk_mul_f32 v[78:79], v[78:79], s[76:77]
    v_exp_f32 v76, v76
    v_exp_f32 v77, v77
    v_exp_f32 v78, v78
    v_exp_f32 v79, v79
    v_pk_add_f32 v[76:77], v[76:77], 1.0 op_sel_hi:[1,0]
    v_pk_add_f32 v[78:79], v[78:79], 1.0 op_sel_hi:[1,0]
    v_rcp_f32 v76, v76
    v_rcp_f32 v77, v77
    v_rcp_f32 v78, v78
    v_rcp_f32 v79, v79
    v_pk_mul_f32 v[76:77], v[76:77], v[68:69]
    v_pk_mul_f32 v[78:79], v[78:79], v[70:71]
    v_cvt_pk_bf16_f32 v68, v76, v77
    v_cvt_pk_bf16_f32 v69, v78, v79
    v_pk_mul_f32 v[92:93], v[92:93], s[76:77]
    v_pk_mul_f32 v[94:95], v[94:95], s[76:77]
    v_exp_f32 v92, v92
    v_exp_f32 v93, v93
    v_exp_f32 v94, v94
    v_exp_f32 v95, v95
    v_pk_add_f32 v[92:93], v[92:93], 1.0 op_sel_hi:[1,0]
    v_pk_add_f32 v[94:95], v[94:95], 1.0 op_sel_hi:[1,0]
    v_rcp_f32 v92, v92
    v_rcp_f32 v93, v93
    v_rcp_f32 v94, v94
    v_rcp_f32 v95, v95
    v_pk_mul_f32 v[92:93], v[92:93], v[84:85]
    v_pk_mul_f32 v[94:95], v[94:95], v[86:87]
    v_cvt_pk_bf16_f32 v84, v92, v93
    v_cvt_pk_bf16_f32 v85, v94, v95
    v_pk_mul_f32 v[108:109], v[108:109], s[76:77]
    v_pk_mul_f32 v[110:111], v[110:111], s[76:77]
    v_exp_f32 v108, v108
    v_exp_f32 v109, v109
    v_exp_f32 v110, v110
    v_exp_f32 v111, v111
    v_pk_add_f32 v[108:109], v[108:109], 1.0 op_sel_hi:[1,0]
    v_pk_add_f32 v[110:111], v[110:111], 1.0 op_sel_hi:[1,0]
    v_rcp_f32 v108, v108
    v_rcp_f32 v109, v109
    v_rcp_f32 v110, v110
    v_rcp_f32 v111, v111
    v_pk_mul_f32 v[108:109], v[108:109], v[100:101]
    v_pk_mul_f32 v[110:111], v[110:111], v[102:103]
    v_cvt_pk_bf16_f32 v100, v108, v109
    v_cvt_pk_bf16_f32 v101, v110, v111
    v_pk_mul_f32 v[124:125], v[124:125], s[76:77]
    v_pk_mul_f32 v[126:127], v[126:127], s[76:77]
    v_exp_f32 v124, v124
    v_exp_f32 v125, v125
    v_exp_f32 v126, v126
    v_exp_f32 v127, v127
    v_pk_add_f32 v[124:125], v[124:125], 1.0 op_sel_hi:[1,0]
    v_pk_add_f32 v[126:127], v[126:127], 1.0 op_sel_hi:[1,0]
    v_rcp_f32 v124, v124
    v_rcp_f32 v125, v125
    v_rcp_f32 v126, v126
    v_rcp_f32 v127, v127
    v_pk_mul_f32 v[124:125], v[124:125], v[116:117]
    v_pk_mul_f32 v[126:127], v[126:127], v[118:119]
    v_cvt_pk_bf16_f32 v116, v124, v125
    v_cvt_pk_bf16_f32 v117, v126, v127
    v_pk_mul_f32 v[140:141], v[140:141], s[76:77]
    v_pk_mul_f32 v[142:143], v[142:143], s[76:77]
    v_exp_f32 v140, v140
    v_exp_f32 v141, v141
    v_exp_f32 v142, v142
    v_exp_f32 v143, v143
    v_pk_add_f32 v[140:141], v[140:141], 1.0 op_sel_hi:[1,0]
    v_pk_add_f32 v[142:143], v[142:143], 1.0 op_sel_hi:[1,0]
    v_rcp_f32 v140, v140
    v_rcp_f32 v141, v141
    v_rcp_f32 v142, v142
    v_rcp_f32 v143, v143
    v_pk_mul_f32 v[140:141], v[140:141], v[132:133]
    v_pk_mul_f32 v[142:143], v[142:143], v[134:135]
    v_cvt_pk_bf16_f32 v132, v140, v141
    v_cvt_pk_bf16_f32 v133, v142, v143
    v_pk_mul_f32 v[156:157], v[156:157], s[76:77]
    v_pk_mul_f32 v[158:159], v[158:159], s[76:77]
    v_exp_f32 v156, v156
    v_exp_f32 v157, v157
    v_exp_f32 v158, v158
    v_exp_f32 v159, v159
    v_pk_add_f32 v[156:157], v[156:157], 1.0 op_sel_hi:[1,0]
    v_pk_add_f32 v[158:159], v[158:159], 1.0 op_sel_hi:[1,0]
    v_rcp_f32 v156, v156
    v_rcp_f32 v157, v157
    v_rcp_f32 v158, v158
    v_rcp_f32 v159, v159
    v_pk_mul_f32 v[156:157], v[156:157], v[148:149]
    v_pk_mul_f32 v[158:159], v[158:159], v[150:151]
    v_cvt_pk_bf16_f32 v148, v156, v157
    v_cvt_pk_bf16_f32 v149, v158, v159
    ds_write_b64 v14, v[20:21] offset:18944
    ds_write_b64 v14, v[36:37] offset:18976
    ds_write_b64 v14, v[52:53] offset:19008
    ds_write_b64 v14, v[68:69] offset:19040
    ds_write_b64 v14, v[84:85] offset:19072
    ds_write_b64 v14, v[100:101] offset:19104
    ds_write_b64 v14, v[116:117] offset:19136
    ds_write_b64 v14, v[132:133] offset:19168
    ds_write_b64 v14, v[148:149] offset:19200
    s_waitcnt lgkmcnt(0)
    s_barrier
    s_add_u32 m0, s74, 122880
    s_add_u32 s75, s19, 7
    s_and_b32 s75, s75, 7
    s_lshl_b32 s75, s75, 16
    s_add_u32 s75, s75, 32768
    buffer_load_dwordx4 v3, s[28:31], s75 offen lds
    s_add_u32 m0, s74, 126976
    s_add_u32 s75, s19, 7
    s_and_b32 s75, s75, 7
    s_lshl_b32 s75, s75, 16
    s_add_u32 s75, s75, 49152
    buffer_load_dwordx4 v3, s[28:31], s75 offen lds
    s_setprio 3
    s_cmp_lg_u32 s48, 0
    s_cbranch_scc1 L_waitgo
    s_setprio 3
    s_mov_b64 exec, 0xff
    s_mov_b32 s3, 0
L_pollA:
    buffer_load_dwordx2 v[28:29], v234, s[40:43], 0 offen offset:0 sc1
    s_add_u32 s3, s3, 1
    s_waitcnt vmcnt(0)
    v_cmp_eq_u64 vcc, v[250:251], v[28:29]
    s_nop 4
    s_cbranch_vccz L_pollA_done
    s_cmp_lt_u32 s3, 24
    s_cbranch_scc1 L_pollA
    buffer_load_ubyte v30, v248, s[44:47], 0 offen sc1
    s_waitcnt vmcnt(0)
    v_cmp_ne_u32 s[72:73], 2, v30
    s_nop 4
    s_and_b64 s[72:73], s[72:73], vcc
    s_cbranch_scc0 L_pollA_done
    s_sleep 8
    s_cmp_lt_u32 s3, 0x80000
    s_cbranch_scc1 L_pollA
L_pollA_done:
    s_mov_b64 exec, -1
    ds_write_b32 v15, v5 offset:8
    s_branch L_go
L_waitgo:
    s_mov_b32 s75, 0
L_wg:
    ds_read_b32 v7, v15 offset:8
    s_add_u32 s75, s75, 1
    s_waitcnt lgkmcnt(0)
    v_cmp_ne_u32 vcc, 1, v7
    s_cmp_gt_u32 s75, 0x800000
    s_cbranch_scc1 L_wg_d
    s_nop 2
    s_cbranch_vccz L_wg_d
    s_sleep 1
    s_branch L_wg
L_wg_d:
L_go:
    s_waitcnt lgkmcnt(0)
    buffer_load_dwordx4 v[96:99], v232, s[40:43], s62 offen offset:0 sc1
    buffer_load_dwordx4 v[100:103], v233, s[40:43], s62 offen offset:0 sc1
    buffer_load_dwordx4 v[104:107], v232, s[40:43], s63 offen offset:0 sc1
    buffer_load_dwordx4 v[108:111], v233, s[40:43], s63 offen offset:0 sc1
    buffer_load_dwordx4 v[112:115], v232, s[40:43], s64 offen offset:0 sc1
    buffer_load_dwordx4 v[116:119], v233, s[40:43], s64 offen offset:0 sc1
    s_setprio 0
    s_mov_b32 s75, 0
L_gate:
    ds_read_b32 v7, v1 offset:0
    s_add_u32 s75, s75, 1
    s_waitcnt lgkmcnt(0)
    v_cmp_ne_u32 vcc, 1, v7
    s_cmp_gt_u32 s75, 0x800000
    s_cbranch_scc1 L_gate_d
    s_nop 2
    s_cbranch_vccz L_gate_d
    s_sleep 1
    s_branch L_gate
L_gate_d:
    ds_read_b64_tr_b16 v[160:161], v224 offset:0
    ds_read_b64_tr_b16 v[162:163], v224 offset:1024
    ds_read_b64_tr_b16 v[164:165], v225 offset:0
    ds_read_b64_tr_b16 v[166:167], v225 offset:1024
    ds_read_b64_tr_b16 v[168:169], v226 offset:0
    ds_read_b64_tr_b16 v[170:171], v226 offset:1024
    ds_read_b64_tr_b16 v[172:173], v227 offset:0
    ds_read_b64_tr_b16 v[174:175], v227 offset:1024
    ds_read_b64_tr_b16 v[176:177], v228 offset:0
    ds_read_b64_tr_b16 v[178:179], v228 offset:1024
    ds_read_b64_tr_b16 v[180:181], v229 offset:0
    ds_read_b64_tr_b16 v[182:183], v229 offset:1024
    s_waitcnt vmcnt(4)
    s_waitcnt lgkmcnt(10)
    v_mfma_f32_16x16x32_bf16 v[32:35], v[160:163], v[96:99], 0
    ds_read_b64_tr_b16 v[184:185], v230 offset:0
    ds_read_b64_tr_b16 v[186:187], v230 offset:1024
    v_mfma_f32_16x16x32_bf16 v[64:67], v[160:163], v[100:103], 0
    s_waitcnt lgkmcnt(10)
    v_mfma_f32_16x16x32_bf16 v[36:39], v[164:167], v[96:99], 0
    ds_read_b64_tr_b16 v[188:189], v231 offset:0
    ds_read_b64_tr_b16 v[190:191], v231 offset:1024
    v_mfma_f32_16x16x32_bf16 v[68:71], v[164:167], v[100:103], 0
    buffer_load_dwordx4 v[120:123], v232, s[40:43], s65 offen offset:0 sc1
    s_waitcnt lgkmcnt(10)
    v_mfma_f32_16x16x32_bf16 v[40:43], v[168:171], v[96:99], 0
    v_add_u32 v16, 65536, v224
    ds_read_b64_tr_b16 v[160:161], v224 offset:8192
    ds_read_b64_tr_b16 v[162:163], v224 offset:9216
    v_mfma_f32_16x16x32_bf16 v[72:75], v[168:171], v[100:103], 0
    s_waitcnt lgkmcnt(10)
    v_mfma_f32_16x16x32_bf16 v[44:47], v[172:175], v[96:99], 0
    v_add_u32 v17, 65536, v225
    ds_read_b64_tr_b16 v[164:165], v225 offset:8192
    ds_read_b64_tr_b16 v[166:167], v225 offset:9216
    v_mfma_f32_16x16x32_bf16 v[76:79], v[172:175], v[100:103], 0
    s_waitcnt lgkmcnt(10)
    v_mfma_f32_16x16x32_bf16 v[48:51], v[176:179], v[96:99], 0
    v_add_u32 v18, 65536, v226
    ds_read_b64_tr_b16 v[168:169], v226 offset:8192
    ds_read_b64_tr_b16 v[170:171], v226 offset:9216
    v_mfma_f32_16x16x32_bf16 v[80:83], v[176:179], v[100:103], 0
    s_waitcnt lgkmcnt(10)
    v_mfma_f32_16x16x32_bf16 v[52:55], v[180:183], v[96:99], 0
    v_add_u32 v19, 65536, v227
    ds_read_b64_tr_b16 v[172:173], v227 offset:8192
    ds_read_b64_tr_b16 v[174:175], v227 offset:9216
    v_mfma_f32_16x16x32_bf16 v[84:87], v[180:183], v[100:103], 0
    buffer_load_dwordx4 v[124:127], v233, s[40:43], s65 offen offset:0 sc1
    s_waitcnt lgkmcnt(10)
    v_mfma_f32_16x16x32_bf16 v[56:59], v[184:187], v[96:99], 0
    v_add_u32 v20, 65536, v228
    ds_read_b64_tr_b16 v[176:177], v228 offset:8192
    ds_read_b64_tr_b16 v[178:179], v228 offset:9216
    v_mfma_f32_16x16x32_bf16 v[88:91], v[184:187], v[100:103], 0
    s_waitcnt lgkmcnt(10)
    v_mfma_f32_16x16x32_bf16 v[60:63], v[188:191], v[96:99], 0
    v_add_u32 v21, 65536, v229
    ds_read_b64_tr_b16 v[180:181], v229 offset:8192
    ds_read_b64_tr_b16 v[182:183], v229 offset:9216
    v_mfma_f32_16x16x32_bf16 v[92:95], v[188:191], v[100:103], 0
    s_waitcnt vmcnt(4)
    s_waitcnt lgkmcnt(10)
    v_mfma_f32_16x16x32_bf16 v[32:35], v[160:163], v[104:107], v[32:35]
    v_add_u32 v22, 65536, v230
    ds_read_b64_tr_b16 v[184:185], v230 offset:8192
    ds_read_b64_tr_b16 v[186:187], v230 offset:9216
    v_mfma_f32_16x16x32_bf16 v[64:67], v[160:163], v[108:111], v[64:67]
    s_waitcnt lgkmcnt(10)
    v_mfma_f32_16x16x32_bf16 v[36:39], v[164:167], v[104:107], v[36:39]
    v_add_u32 v23, 65536, v231
    ds_read_b64_tr_b16 v[188:189], v231 offset:8192
    ds_read_b64_tr_b16 v[190:191], v231 offset:9216
    v_mfma_f32_16x16x32_bf16 v[68:71], v[164:167], v[108:111], v[68:71]
    buffer_load_dwordx4 v[128:131], v232, s[40:43], s66 offen offset:0 sc1
    s_waitcnt lgkmcnt(10)
    v_mfma_f32_16x16x32_bf16 v[40:43], v[168:171], v[104:107], v[40:43]
    ds_read_b64_tr_b16 v[160:161], v224 offset:16384
    ds_read_b64_tr_b16 v[162:163], v224 offset:17408
    v_mfma_f32_16x16x32_bf16 v[72:75], v[168:171], v[108:111], v[72:75]
    s_waitcnt lgkmcnt(10)
    v_mfma_f32_16x16x32_bf16 v[44:47], v[172:175], v[104:107], v[44:47]
    ds_read_b64_tr_b16 v[164:165], v225 offset:16384
    ds_read_b64_tr_b16 v[166:167], v225 offset:17408
    v_mfma_f32_16x16x32_bf16 v[76:79], v[172:175], v[108:111], v[76:79]
    s_waitcnt lgkmcnt(10)
    v_mfma_f32_16x16x32_bf16 v[48:51], v[176:179], v[104:107], v[48:51]
    ds_read_b64_tr_b16 v[168:169], v226 offset:16384
    ds_read_b64_tr_b16 v[170:171], v226 offset:17408
    v_mfma_f32_16x16x32_bf16 v[80:83], v[176:179], v[108:111], v[80:83]
    s_waitcnt lgkmcnt(10)
    v_mfma_f32_16x16x32_bf16 v[52:55], v[180:183], v[104:107], v[52:55]
    ds_read_b64_tr_b16 v[172:173], v227 offset:16384
    ds_read_b64_tr_b16 v[174:175], v227 offset:17408
    v_mfma_f32_16x16x32_bf16 v[84:87], v[180:183], v[108:111], v[84:87]
    buffer_load_dwordx4 v[132:135], v233, s[40:43], s66 offen offset:0 sc1
    s_waitcnt lgkmcnt(10)
    v_mfma_f32_16x16x32_bf16 v[56:59], v[184:187], v[104:107], v[56:59]
    ds_read_b64_tr_b16 v[176:177], v228 offset:16384
    ds_read_b64_tr_b16 v[178:179], v228 offset:17408
    v_mfma_f32_16x16x32_bf16 v[88:91], v[184:187], v[108:111], v[88:91]
    s_waitcnt lgkmcnt(10)
    v_mfma_f32_16x16x32_bf16 v[60:63], v[188:191], v[104:107], v[60:63]
    ds_read_b64_tr_b16 v[180:181], v229 offset:16384
    ds_read_b64_tr_b16 v[182:183], v229 offset:17408
    v_mfma_f32_16x16x32_bf16 v[92:95], v[188:191], v[108:111], v[92:95]
    s_waitcnt vmcnt(4)
    s_waitcnt lgkmcnt(10)
    v_mfma_f32_16x16x32_bf16 v[32:35], v[160:163], v[112:115], v[32:35]
    ds_read_b64_tr_b16 v[184:185], v230 offset:16384
    ds_read_b64_tr_b16 v[186:187], v230 offset:17408
    v_mfma_f32_16x16x32_bf16 v[64:67], v[160:163], v[116:119], v[64:67]
    s_waitcnt lgkmcnt(10)
    v_mfma_f32_16x16x32_bf16 v[36:39], v[164:167], v[112:115], v[36:39]
    ds_read_b64_tr_b16 v[188:189], v231 offset:16384
    ds_read_b64_tr_b16 v[190:191], v231 offset:17408
    v_mfma_f32_16x16x32_bf16 v[68:71], v[164:167], v[116:119], v[68:71]
    buffer_load_dwordx4 v[136:139], v232, s[40:43], s67 offen offset:0 sc1
    s_waitcnt lgkmcnt(10)
    v_mfma_f32_16x16x32_bf16 v[40:43], v[168:171], v[112:115], v[40:43]
    ds_read_b64_tr_b16 v[160:161], v224 offset:24576
    ds_read_b64_tr_b16 v[162:163], v224 offset:25600
    v_mfma_f32_16x16x32_bf16 v[72:75], v[168:171], v[116:119], v[72:75]
    s_waitcnt lgkmcnt(10)
    v_mfma_f32_16x16x32_bf16 v[44:47], v[172:175], v[112:115], v[44:47]
    ds_read_b64_tr_b16 v[164:165], v225 offset:24576
    ds_read_b64_tr_b16 v[166:167], v225 offset:25600
    v_mfma_f32_16x16x32_bf16 v[76:79], v[172:175], v[116:119], v[76:79]
    s_waitcnt lgkmcnt(10)
    v_mfma_f32_16x16x32_bf16 v[48:51], v[176:179], v[112:115], v[48:51]
    ds_read_b64_tr_b16 v[168:169], v226 offset:24576
    ds_read_b64_tr_b16 v[170:171], v226 offset:25600
    v_mfma_f32_16x16x32_bf16 v[80:83], v[176:179], v[116:119], v[80:83]
    s_waitcnt lgkmcnt(10)
    v_mfma_f32_16x16x32_bf16 v[52:55], v[180:183], v[112:115], v[52:55]
    ds_read_b64_tr_b16 v[172:173], v227 offset:24576
    ds_read_b64_tr_b16 v[174:175], v227 offset:25600
    v_mfma_f32_16x16x32_bf16 v[84:87], v[180:183], v[116:119], v[84:87]
    buffer_load_dwordx4 v[140:143], v233, s[40:43], s67 offen offset:0 sc1
    s_waitcnt lgkmcnt(10)
    v_mfma_f32_16x16x32_bf16 v[56:59], v[184:187], v[112:115], v[56:59]
    ds_read_b64_tr_b16 v[176:177], v228 offset:24576
    ds_read_b64_tr_b16 v[178:179], v228 offset:25600
    v_mfma_f32_16x16x32_bf16 v[88:91], v[184:187], v[116:119], v[88:91]
    s_waitcnt lgkmcnt(10)
    v_mfma_f32_16x16x32_bf16 v[60:63], v[188:191], v[112:115], v[60:63]
    ds_read_b64_tr_b16 v[180:181], v229 offset:24576
    ds_read_b64_tr_b16 v[182:183], v229 offset:25600
    v_mfma_f32_16x16x32_bf16 v[92:95], v[188:191], v[116:119], v[92:95]
    s_waitcnt vmcnt(4)
    s_waitcnt lgkmcnt(10)
    v_mfma_f32_16x16x32_bf16 v[32:35], v[160:163], v[120:123], v[32:35]
    ds_read_b64_tr_b16 v[184:185], v230 offset:24576
    ds_read_b64_tr_b16 v[186:187], v230 offset:25600
    v_mfma_f32_16x16x32_bf16 v[64:67], v[160:163], v[124:127], v[64:67]
    s_waitcnt lgkmcnt(10)
    v_mfma_f32_16x16x32_bf16 v[36:39], v[164:167], v[120:123], v[36:39]
    ds_read_b64_tr_b16 v[188:189], v231 offset:24576
    ds_read_b64_tr_b16 v[190:191], v231 offset:25600
    v_mfma_f32_16x16x32_bf16 v[68:71], v[164:167], v[124:127], v[68:71]
    buffer_load_dwordx4 v[144:147], v232, s[40:43], s68 offen offset:0 sc1
    s_waitcnt lgkmcnt(10)
    v_mfma_f32_16x16x32_bf16 v[40:43], v[168:171], v[120:123], v[40:43]
    ds_read_b64_tr_b16 v[160:161], v224 offset:32768
    ds_read_b64_tr_b16 v[162:163], v224 offset:33792
    v_mfma_f32_16x16x32_bf16 v[72:75], v[168:171], v[124:127], v[72:75]
    s_waitcnt lgkmcnt(10)
    v_mfma_f32_16x16x32_bf16 v[44:47], v[172:175], v[120:123], v[44:47]
    ds_read_b64_tr_b16 v[164:165], v225 offset:32768
    ds_read_b64_tr_b16 v[166:167], v225 offset:33792
    v_mfma_f32_16x16x32_bf16 v[76:79], v[172:175], v[124:127], v[76:79]
    s_waitcnt lgkmcnt(10)
    v_mfma_f32_16x16x32_bf16 v[48:51], v[176:179], v[120:123], v[48:51]
    ds_read_b64_tr_b16 v[168:169], v226 offset:32768
    ds_read_b64_tr_b16 v[170:171], v226 offset:33792
    v_mfma_f32_16x16x32_bf16 v[80:83], v[176:179], v[124:127], v[80:83]
    s_waitcnt lgkmcnt(10)
    v_mfma_f32_16x16x32_bf16 v[52:55], v[180:183], v[120:123], v[52:55]
    ds_read_b64_tr_b16 v[172:173], v227 offset:32768
    ds_read_b64_tr_b16 v[174:175], v227 offset:33792
    v_mfma_f32_16x16x32_bf16 v[84:87], v[180:183], v[124:127], v[84:87]
    buffer_load_dwordx4 v[148:151], v233, s[40:43], s68 offen offset:0 sc1
    s_waitcnt lgkmcnt(10)
    v_mfma_f32_16x16x32_bf16 v[56:59], v[184:187], v[120:123], v[56:59]
    ds_read_b64_tr_b16 v[176:177], v228 offset:32768
    ds_read_b64_tr_b16 v[178:179], v228 offset:33792
    v_mfma_f32_16x16x32_bf16 v[88:91], v[184:187], v[124:127], v[88:91]
    s_waitcnt lgkmcnt(10)
    v_mfma_f32_16x16x32_bf16 v[60:63], v[188:191], v[120:123], v[60:63]
    ds_read_b64_tr_b16 v[180:181], v229 offset:32768
    ds_read_b64_tr_b16 v[182:183], v229 offset:33792
    v_mfma_f32_16x16x32_bf16 v[92:95], v[188:191], v[124:127], v[92:95]
    s_waitcnt vmcnt(4)
    s_waitcnt lgkmcnt(10)
    v_mfma_f32_16x16x32_bf16 v[32:35], v[160:163], v[128:131], v[32:35]
    ds_read_b64_tr_b16 v[184:185], v230 offset:32768
    ds_read_b64_tr_b16 v[186:187], v230 offset:33792
    v_mfma_f32_16x16x32_bf16 v[64:67], v[160:163], v[132:135], v[64:67]
    s_waitcnt lgkmcnt(10)
    v_mfma_f32_16x16x32_bf16 v[36:39], v[164:167], v[128:131], v[36:39]
    ds_read_b64_tr_b16 v[188:189], v231 offset:32768
    ds_read_b64_tr_b16 v[190:191], v231 offset:33792
    v_mfma_f32_16x16x32_bf16 v[68:71], v[164:167], v[132:135], v[68:71]
    buffer_load_dwordx4 v[152:155], v232, s[40:43], s69 offen offset:0 sc1
    s_waitcnt lgkmcnt(10)
    v_mfma_f32_16x16x32_bf16 v[40:43], v[168:171], v[128:131], v[40:43]
    ds_read_b64_tr_b16 v[160:161], v224 offset:40960
    ds_read_b64_tr_b16 v[162:163], v224 offset:41984
    v_mfma_f32_16x16x32_bf16 v[72:75], v[168:171], v[132:135], v[72:75]
    s_waitcnt lgkmcnt(10)
    v_mfma_f32_16x16x32_bf16 v[44:47], v[172:175], v[128:131], v[44:47]
    ds_read_b64_tr_b16 v[164:165], v225 offset:40960
    ds_read_b64_tr_b16 v[166:167], v225 offset:41984
    v_mfma_f32_16x16x32_bf16 v[76:79], v[172:175], v[132:135], v[76:79]
    s_waitcnt lgkmcnt(10)
    v_mfma_f32_16x16x32_bf16 v[48:51], v[176:179], v[128:131], v[48:51]
    ds_read_b64_tr_b16 v[168:169], v226 offset:40960
    ds_read_b64_tr_b16 v[170:171], v226 offset:41984
    v_mfma_f32_16x16x32_bf16 v[80:83], v[176:179], v[132:135], v[80:83]
    s_waitcnt lgkmcnt(10)
    v_mfma_f32_16x16x32_bf16 v[52:55], v[180:183], v[128:131], v[52:55]
    ds_read_b64_tr_b16 v[172:173], v227 offset:40960
    ds_read_b64_tr_b16 v[174:175], v227 offset:41984
    v_mfma_f32_16x16x32_bf16 v[84:87], v[180:183], v[132:135], v[84:87]
    buffer_load_dwordx4 v[156:159], v233, s[40:43], s69 offen offset:0 sc1
    s_waitcnt lgkmcnt(10)
    v_mfma_f32_16x16x32_bf16 v[56:59], v[184:187], v[128:131], v[56:59]
    ds_read_b64_tr_b16 v[176:177], v228 offset:40960
    ds_read_b64_tr_b16 v[178:179], v228 offset:41984
    v_mfma_f32_16x16x32_bf16 v[88:91], v[184:187], v[132:135], v[88:91]
    s_waitcnt lgkmcnt(10)
    v_mfma_f32_16x16x32_bf16 v[60:63], v[188:191], v[128:131], v[60:63]
    ds_read_b64_tr_b16 v[180:181], v229 offset:40960
    ds_read_b64_tr_b16 v[182:183], v229 offset:41984
    v_mfma_f32_16x16x32_bf16 v[92:95], v[188:191], v[132:135], v[92:95]
    s_waitcnt vmcnt(4)
    s_waitcnt lgkmcnt(10)
    v_mfma_f32_16x16x32_bf16 v[32:35], v[160:163], v[136:139], v[32:35]
    ds_read_b64_tr_b16 v[184:185], v230 offset:40960
    ds_read_b64_tr_b16 v[186:187], v230 offset:41984
    v_mfma_f32_16x16x32_bf16 v[64:67], v[160:163], v[140:143], v[64:67]
    s_waitcnt lgkmcnt(10)
    v_mfma_f32_16x16x32_bf16 v[36:39], v[164:167], v[136:139], v[36:39]
    ds_read_b64_tr_b16 v[188:189], v231 offset:40960
    ds_read_b64_tr_b16 v[190:191], v231 offset:41984
    v_mfma_f32_16x16x32_bf16 v[68:71], v[164:167], v[140:143], v[68:71]
    s_waitcnt lgkmcnt(10)
    v_mfma_f32_16x16x32_bf16 v[40:43], v[168:171], v[136:139], v[40:43]
    ds_read_b64_tr_b16 v[160:161], v16 offset:40960
    ds_read_b64_tr_b16 v[162:163], v16 offset:41984
    v_mfma_f32_16x16x32_bf16 v[72:75], v[168:171], v[140:143], v[72:75]
    s_waitcnt lgkmcnt(10)
    v_mfma_f32_16x16x32_bf16 v[44:47], v[172:175], v[136:139], v[44:47]
    ds_read_b64_tr_b16 v[164:165], v17 offset:40960
    ds_read_b64_tr_b16 v[166:167], v17 offset:41984
    v_mfma_f32_16x16x32_bf16 v[76:79], v[172:175], v[140:143], v[76:79]
    s_waitcnt lgkmcnt(10)
    v_mfma_f32_16x16x32_bf16 v[48:51], v[176:179], v[136:139], v[48:51]
    ds_read_b64_tr_b16 v[168:169], v18 offset:40960
    ds_read_b64_tr_b16 v[170:171], v18 offset:41984
    v_mfma_f32_16x16x32_bf16 v[80:83], v[176:179], v[140:143], v[80:83]
    s_waitcnt lgkmcnt(10)
    v_mfma_f32_16x16x32_bf16 v[52:55], v[180:183], v[136:139], v[52:55]
    ds_read_b64_tr_b16 v[172:173], v19 offset:40960
    ds_read_b64_tr_b16 v[174:175], v19 offset:41984
    v_mfma_f32_16x16x32_bf16 v[84:87], v[180:183], v[140:143], v[84:87]
    s_waitcnt lgkmcnt(10)
    v_mfma_f32_16x16x32_bf16 v[56:59], v[184:187], v[136:139], v[56:59]
    ds_read_b64_tr_b16 v[176:177], v20 offset:40960
    ds_read_b64_tr_b16 v[178:179], v20 offset:41984
    v_mfma_f32_16x16x32_bf16 v[88:91], v[184:187], v[140:143], v[88:91]
    s_waitcnt lgkmcnt(10)
    v_mfma_f32_16x16x32_bf16 v[60:63], v[188:191], v[136:139], v[60:63]
    ds_read_b64_tr_b16 v[180:181], v21 offset:40960
    ds_read_b64_tr_b16 v[182:183], v21 offset:41984
    v_mfma_f32_16x16x32_bf16 v[92:95], v[188:191], v[140:143], v[92:95]
    s_barrier
    s_waitcnt vmcnt(2)
    s_waitcnt lgkmcnt(10)
    v_mfma_f32_16x16x32_bf16 v[32:35], v[160:163], v[144:147], v[32:35]
    ds_read_b64_tr_b16 v[184:185], v22 offset:40960
    ds_read_b64_tr_b16 v[186:187], v22 offset:41984
    v_mfma_f32_16x16x32_bf16 v[64:67], v[160:163], v[148:151], v[64:67]
    buffer_load_dwordx4 v[96:99], v232, s[40:43], s62 offen offset:1024 sc1
    s_waitcnt lgkmcnt(10)
    v_mfma_f32_16x16x32_bf16 v[36:39], v[164:167], v[144:147], v[36:39]
    ds_read_b64_tr_b16 v[188:189], v23 offset:40960
    ds_read_b64_tr_b16 v[190:191], v23 offset:41984
    v_mfma_f32_16x16x32_bf16 v[68:71], v[164:167], v[148:151], v[68:71]
    s_waitcnt lgkmcnt(10)
    v_mfma_f32_16x16x32_bf16 v[40:43], v[168:171], v[144:147], v[40:43]
    ds_read_b64_tr_b16 v[160:161], v16 offset:49152
    ds_read_b64_tr_b16 v[162:163], v16 offset:50176
    v_mfma_f32_16x16x32_bf16 v[72:75], v[168:171], v[148:151], v[72:75]
    s_waitcnt lgkmcnt(10)
    v_mfma_f32_16x16x32_bf16 v[44:47], v[172:175], v[144:147], v[44:47]
    ds_read_b64_tr_b16 v[164:165], v17 offset:49152
    ds_read_b64_tr_b16 v[166:167], v17 offset:50176
    v_mfma_f32_16x16x32_bf16 v[76:79], v[172:175], v[148:151], v[76:79]
    buffer_load_dwordx4 v[100:103], v233, s[40:43], s62 offen offset:1024 sc1
    s_waitcnt lgkmcnt(10)
    v_mfma_f32_16x16x32_bf16 v[48:51], v[176:179], v[144:147], v[48:51]
    ds_read_b64_tr_b16 v[168:169], v18 offset:49152
    ds_read_b64_tr_b16 v[170:171], v18 offset:50176
    v_mfma_f32_16x16x32_bf16 v[80:83], v[176:179], v[148:151], v[80:83]
    s_waitcnt lgkmcnt(10)
    v_mfma_f32_16x16x32_bf16 v[52:55], v[180:183], v[144:147], v[52:55]
    ds_read_b64_tr_b16 v[172:173], v19 offset:49152
    ds_read_b64_tr_b16 v[174:175], v19 offset:50176
    v_mfma_f32_16x16x32_bf16 v[84:87], v[180:183], v[148:151], v[84:87]
    s_waitcnt lgkmcnt(10)
    v_mfma_f32_16x16x32_bf16 v[56:59], v[184:187], v[144:147], v[56:59]
    ds_read_b64_tr_b16 v[176:177], v20 offset:49152
    ds_read_b64_tr_b16 v[178:179], v20 offset:50176
    v_mfma_f32_16x16x32_bf16 v[88:91], v[184:187], v[148:151], v[88:91]
    buffer_load_dwordx4 v[104:107], v232, s[40:43], s63 offen offset:1024 sc1
    s_waitcnt lgkmcnt(10)
    v_mfma_f32_16x16x32_bf16 v[60:63], v[188:191], v[144:147], v[60:63]
    ds_read_b64_tr_b16 v[180:181], v21 offset:49152
    ds_read_b64_tr_b16 v[182:183], v21 offset:50176
    v_mfma_f32_16x16x32_bf16 v[92:95], v[188:191], v[148:151], v[92:95]
    s_waitcnt vmcnt(3)
    s_waitcnt lgkmcnt(10)
    v_mfma_f32_16x16x32_bf16 v[32:35], v[160:163], v[152:155], v[32:35]
    ds_read_b64_tr_b16 v[184:185], v22 offset:49152
    ds_read_b64_tr_b16 v[186:187], v22 offset:50176
    v_mfma_f32_16x16x32_bf16 v[64:67], v[160:163], v[156:159], v[64:67]
    buffer_load_dwordx4 v[108:111], v233, s[40:43], s63 offen offset:1024 sc1
    s_waitcnt lgkmcnt(10)
    v_mfma_f32_16x16x32_bf16 v[36:39], v[164:167], v[152:155], v[36:39]
    ds_read_b64_tr_b16 v[188:189], v23 offset:49152
    ds_read_b64_tr_b16 v[190:191], v23 offset:50176
    v_mfma_f32_16x16x32_bf16 v[68:71], v[164:167], v[156:159], v[68:71]
    s_waitcnt lgkmcnt(10)
    v_mfma_f32_16x16x32_bf16 v[40:43], v[168:171], v[152:155], v[40:43]
    ds_read_b64_tr_b16 v[160:161], v224 offset:49152
    ds_read_b64_tr_b16 v[162:163], v224 offset:50176
    v_mfma_f32_16x16x32_bf16 v[72:75], v[168:171], v[156:159], v[72:75]
    s_waitcnt lgkmcnt(10)
    v_mfma_f32_16x16x32_bf16 v[44:47], v[172:175], v[152:155], v[44:47]
    ds_read_b64_tr_b16 v[164:165], v225 offset:49152
    ds_read_b64_tr_b16 v[166:167], v225 offset:50176
    v_mfma_f32_16x16x32_bf16 v[76:79], v[172:175], v[156:159], v[76:79]
    buffer_load_dwordx4 v[112:115], v232, s[40:43], s64 offen offset:1024 sc1
    s_waitcnt lgkmcnt(10)
    v_mfma_f32_16x16x32_bf16 v[48:51], v[176:179], v[152:155], v[48:51]
    ds_read_b64_tr_b16 v[168:169], v226 offset:49152
    ds_read_b64_tr_b16 v[170:171], v226 offset:50176
    v_mfma_f32_16x16x32_bf16 v[80:83], v[176:179], v[156:159], v[80:83]
    s_waitcnt lgkmcnt(10)
    v_mfma_f32_16x16x32_bf16 v[52:55], v[180:183], v[152:155], v[52:55]
    ds_read_b64_tr_b16 v[172:173], v227 offset:49152
    ds_read_b64_tr_b16 v[174:175], v227 offset:50176
    v_mfma_f32_16x16x32_bf16 v[84:87], v[180:183], v[156:159], v[84:87]
    s_waitcnt lgkmcnt(10)
    v_mfma_f32_16x16x32_bf16 v[56:59], v[184:187], v[152:155], v[56:59]
    ds_read_b64_tr_b16 v[176:177], v228 offset:49152
    ds_read_b64_tr_b16 v[178:179], v228 offset:50176
    v_mfma_f32_16x16x32_bf16 v[88:91], v[184:187], v[156:159], v[88:91]
    buffer_load_dwordx4 v[116:119], v233, s[40:43], s64 offen offset:1024 sc1
    s_waitcnt lgkmcnt(10)
    v_mfma_f32_16x16x32_bf16 v[60:63], v[188:191], v[152:155], v[60:63]
    ds_read_b64_tr_b16 v[180:181], v229 offset:49152
    ds_read_b64_tr_b16 v[182:183], v229 offset:50176
    v_mfma_f32_16x16x32_bf16 v[92:95], v[188:191], v[156:159], v[92:95]
    s_waitcnt vmcnt(4)
    s_waitcnt lgkmcnt(10)
    v_mfma_f32_16x16x32_bf16 v[32:35], v[160:163], v[96:99], v[32:35]
    ds_read_b64_tr_b16 v[184:185], v230 offset:49152
    ds_read_b64_tr_b16 v[186:187], v230 offset:50176
    v_mfma_f32_16x16x32_bf16 v[64:67], v[160:163], v[100:103], v[64:67]
    buffer_load_dwordx4 v[120:123], v232, s[40:43], s65 offen offset:1024 sc1
    s_waitcnt lgkmcnt(10)
    v_mfma_f32_16x16x32_bf16 v[36:39], v[164:167], v[96:99], v[36:39]
    ds_read_b64_tr_b16 v[188:189], v231 offset:49152
    ds_read_b64_tr_b16 v[190:191], v231 offset:50176
    v_mfma_f32_16x16x32_bf16 v[68:71], v[164:167], v[100:103], v[68:71]
    s_waitcnt lgkmcnt(10)
    v_mfma_f32_16x16x32_bf16 v[40:43], v[168:171], v[96:99], v[40:43]
    ds_read_b64_tr_b16 v[160:161], v224 offset:57344
    ds_read_b64_tr_b16 v[162:163], v224 offset:58368
    v_mfma_f32_16x16x32_bf16 v[72:75], v[168:171], v[100:103], v[72:75]
    s_waitcnt lgkmcnt(10)
    v_mfma_f32_16x16x32_bf16 v[44:47], v[172:175], v[96:99], v[44:47]
    ds_read_b64_tr_b16 v[164:165], v225 offset:57344
    ds_read_b64_tr_b16 v[166:167], v225 offset:58368
    v_mfma_f32_16x16x32_bf16 v[76:79], v[172:175], v[100:103], v[76:79]
    buffer_load_dwordx4 v[124:127], v233, s[40:43], s65 offen offset:1024 sc1
    s_waitcnt lgkmcnt(10)
    v_mfma_f32_16x16x32_bf16 v[48:51], v[176:179], v[96:99], v[48:51]
    ds_read_b64_tr_b16 v[168:169], v226 offset:57344
    ds_read_b64_tr_b16 v[170:171], v226 offset:58368
    v_mfma_f32_16x16x32_bf16 v[80:83], v[176:179], v[100:103], v[80:83]
    s_waitcnt lgkmcnt(10)
    v_mfma_f32_16x16x32_bf16 v[52:55], v[180:183], v[96:99], v[52:55]
    ds_read_b64_tr_b16 v[172:173], v227 offset:57344
    ds_read_b64_tr_b16 v[174:175], v227 offset:58368
    v_mfma_f32_16x16x32_bf16 v[84:87], v[180:183], v[100:103], v[84:87]
    s_waitcnt lgkmcnt(10)
    v_mfma_f32_16x16x32_bf16 v[56:59], v[184:187], v[96:99], v[56:59]
    ds_read_b64_tr_b16 v[176:177], v228 offset:57344
    ds_read_b64_tr_b16 v[178:179], v228 offset:58368
    v_mfma_f32_16x16x32_bf16 v[88:91], v[184:187], v[100:103], v[88:91]
    buffer_load_dwordx4 v[128:131], v232, s[40:43], s66 offen offset:1024 sc1
    s_waitcnt lgkmcnt(10)
    v_mfma_f32_16x16x32_bf16 v[60:63], v[188:191], v[96:99], v[60:63]
    ds_read_b64_tr_b16 v[180:181], v229 offset:57344
    ds_read_b64_tr_b16 v[182:183], v229 offset:58368
    v_mfma_f32_16x16x32_bf16 v[92:95], v[188:191], v[100:103], v[92:95]
    s_waitcnt vmcnt(5)
    s_waitcnt lgkmcnt(10)
    v_mfma_f32_16x16x32_bf16 v[32:35], v[160:163], v[104:107], v[32:35]
    ds_read_b64_tr_b16 v[184:185], v230 offset:57344
    ds_read_b64_tr_b16 v[186:187], v230 offset:58368
    v_mfma_f32_16x16x32_bf16 v[64:67], v[160:163], v[108:111], v[64:67]
    buffer_load_dwordx4 v[132:135], v233, s[40:43], s66 offen offset:1024 sc1
    s_waitcnt lgkmcnt(10)
    v_mfma_f32_16x16x32_bf16 v[36:39], v[164:167], v[104:107], v[36:39]
    ds_read_b64_tr_b16 v[188:189], v231 offset:57344
    ds_read_b64_tr_b16 v[190:191], v231 offset:58368
    v_mfma_f32_16x16x32_bf16 v[68:71], v[164:167], v[108:111], v[68:71]
    s_waitcnt lgkmcnt(10)
    v_mfma_f32_16x16x32_bf16 v[40:43], v[168:171], v[104:107], v[40:43]
    ds_read_b64_tr_b16 v[160:161], v16 offset:0
    ds_read_b64_tr_b16 v[162:163], v16 offset:1024
    v_mfma_f32_16x16x32_bf16 v[72:75], v[168:171], v[108:111], v[72:75]
    s_waitcnt lgkmcnt(10)
    v_mfma_f32_16x16x32_bf16 v[44:47], v[172:175], v[104:107], v[44:47]
    ds_read_b64_tr_b16 v[164:165], v17 offset:0
    ds_read_b64_tr_b16 v[166:167], v17 offset:1024
    v_mfma_f32_16x16x32_bf16 v[76:79], v[172:175], v[108:111], v[76:79]
    buffer_load_dwordx4 v[136:139], v232, s[40:43], s67 offen offset:1024 sc1
    s_waitcnt lgkmcnt(10)
    v_mfma_f32_16x16x32_bf16 v[48:51], v[176:179], v[104:107], v[48:51]
    ds_read_b64_tr_b16 v[168:169], v18 offset:0
    ds_read_b64_tr_b16 v[170:171], v18 offset:1024
    v_mfma_f32_16x16x32_bf16 v[80:83], v[176:179], v[108:111], v[80:83]
    s_waitcnt lgkmcnt(10)
    v_mfma_f32_16x16x32_bf16 v[52:55], v[180:183], v[104:107], v[52:55]
    ds_read_b64_tr_b16 v[172:173], v19 offset:0
    ds_read_b64_tr_b16 v[174:175], v19 offset:1024
    v_mfma_f32_16x16x32_bf16 v[84:87], v[180:183], v[108:111], v[84:87]
    s_waitcnt lgkmcnt(10)
    v_mfma_f32_16x16x32_bf16 v[56:59], v[184:187], v[104:107], v[56:59]
    ds_read_b64_tr_b16 v[176:177], v20 offset:0
    ds_read_b64_tr_b16 v[178:179], v20 offset:1024
    v_mfma_f32_16x16x32_bf16 v[88:91], v[184:187], v[108:111], v[88:91]
    buffer_load_dwordx4 v[140:143], v233, s[40:43], s67 offen offset:1024 sc1
    s_waitcnt lgkmcnt(10)
    v_mfma_f32_16x16x32_bf16 v[60:63], v[188:191], v[104:107], v[60:63]
    ds_read_b64_tr_b16 v[180:181], v21 offset:0
    ds_read_b64_tr_b16 v[182:183], v21 offset:1024
    v_mfma_f32_16x16x32_bf16 v[92:95], v[188:191], v[108:111], v[92:95]
    s_waitcnt vmcnt(6)
    s_waitcnt lgkmcnt(10)
    v_mfma_f32_16x16x32_bf16 v[32:35], v[160:163], v[112:115], v[32:35]
    ds_read_b64_tr_b16 v[184:185], v22 offset:0
    ds_read_b64_tr_b16 v[186:187], v22 offset:1024
    v_mfma_f32_16x16x32_bf16 v[64:67], v[160:163], v[116:119], v[64:67]
    buffer_load_dwordx4 v[144:147], v232, s[40:43], s68 offen offset:1024 sc1
    s_waitcnt lgkmcnt(10)
    v_mfma_f32_16x16x32_bf16 v[36:39], v[164:167], v[112:115], v[36:39]
    ds_read_b64_tr_b16 v[188:189], v23 offset:0
    ds_read_b64_tr_b16 v[190:191], v23 offset:1024
    v_mfma_f32_16x16x32_bf16 v[68:71], v[164:167], v[116:119], v[68:71]
    s_waitcnt lgkmcnt(10)
    v_mfma_f32_16x16x32_bf16 v[40:43], v[168:171], v[112:115], v[40:43]
    ds_read_b64_tr_b16 v[160:161], v16 offset:8192
    ds_read_b64_tr_b16 v[162:163], v16 offset:9216
    v_mfma_f32_16x16x32_bf16 v[72:75], v[168:171], v[116:119], v[72:75]
    s_waitcnt lgkmcnt(10)
    v_mfma_f32_16x16x32_bf16 v[44:47], v[172:175], v[112:115], v[44:47]
    ds_read_b64_tr_b16 v[164:165], v17 offset:8192
    ds_read_b64_tr_b16 v[166:167], v17 offset:9216
    v_mfma_f32_16x16x32_bf16 v[76:79], v[172:175], v[116:119], v[76:79]
    buffer_load_dwordx4 v[148:151], v233, s[40:43], s68 offen offset:1024 sc1
    s_waitcnt lgkmcnt(10)
    v_mfma_f32_16x16x32_bf16 v[48:51], v[176:179], v[112:115], v[48:51]
    ds_read_b64_tr_b16 v[168:169], v18 offset:8192
    ds_read_b64_tr_b16 v[170:171], v18 offset:9216
    v_mfma_f32_16x16x32_bf16 v[80:83], v[176:179], v[116:119], v[80:83]
    s_waitcnt lgkmcnt(10)
    v_mfma_f32_16x16x32_bf16 v[52:55], v[180:183], v[112:115], v[52:55]
    ds_read_b64_tr_b16 v[172:173], v19 offset:8192
    ds_read_b64_tr_b16 v[174:175], v19 offset:9216
    v_mfma_f32_16x16x32_bf16 v[84:87], v[180:183], v[116:119], v[84:87]
    s_waitcnt lgkmcnt(10)
    v_mfma_f32_16x16x32_bf16 v[56:59], v[184:187], v[112:115], v[56:59]
    ds_read_b64_tr_b16 v[176:177], v20 offset:8192
    ds_read_b64_tr_b16 v[178:179], v20 offset:9216
    v_mfma_f32_16x16x32_bf16 v[88:91], v[184:187], v[116:119], v[88:91]
    buffer_load_dwordx4 v[152:155], v232, s[40:43], s69 offen offset:1024 sc1
    s_waitcnt lgkmcnt(10)
    v_mfma_f32_16x16x32_bf16 v[60:63], v[188:191], v[112:115], v[60:63]
    ds_read_b64_tr_b16 v[180:181], v21 offset:8192
    ds_read_b64_tr_b16 v[182:183], v21 offset:9216
    v_mfma_f32_16x16x32_bf16 v[92:95], v[188:191], v[116:119], v[92:95]
    s_waitcnt vmcnt(7)
    s_waitcnt lgkmcnt(10)
    v_mfma_f32_16x16x32_bf16 v[32:35], v[160:163], v[120:123], v[32:35]
    ds_read_b64_tr_b16 v[184:185], v22 offset:8192
    ds_read_b64_tr_b16 v[186:187], v22 offset:9216
    v_mfma_f32_16x16x32_bf16 v[64:67], v[160:163], v[124:127], v[64:67]
    buffer_load_dwordx4 v[156:159], v233, s[40:43], s69 offen offset:1024 sc1
    s_waitcnt lgkmcnt(10)
    v_mfma_f32_16x16x32_bf16 v[36:39], v[164:167], v[120:123], v[36:39]
    ds_read_b64_tr_b16 v[188:189], v23 offset:8192
    ds_read_b64_tr_b16 v[190:191], v23 offset:9216
    v_mfma_f32_16x16x32_bf16 v[68:71], v[164:167], v[124:127], v[68:71]
    s_waitcnt lgkmcnt(10)
    v_mfma_f32_16x16x32_bf16 v[40:43], v[168:171], v[120:123], v[40:43]
    ds_read_b64_tr_b16 v[160:161], v16 offset:16384
    ds_read_b64_tr_b16 v[162:163], v16 offset:17408
    v_mfma_f32_16x16x32_bf16 v[72:75], v[168:171], v[124:127], v[72:75]
    s_waitcnt lgkmcnt(10)
    v_mfma_f32_16x16x32_bf16 v[44:47], v[172:175], v[120:123], v[44:47]
    ds_read_b64_tr_b16 v[164:165], v17 offset:16384
    ds_read_b64_tr_b16 v[166:167], v17 offset:17408
    v_mfma_f32_16x16x32_bf16 v[76:79], v[172:175], v[124:127], v[76:79]
    s_waitcnt lgkmcnt(10)
    v_mfma_f32_16x16x32_bf16 v[48:51], v[176:179], v[120:123], v[48:51]
    ds_read_b64_tr_b16 v[168:169], v18 offset:16384
    ds_read_b64_tr_b16 v[170:171], v18 offset:17408
    v_mfma_f32_16x16x32_bf16 v[80:83], v[176:179], v[124:127], v[80:83]
    s_waitcnt lgkmcnt(10)
    v_mfma_f32_16x16x32_bf16 v[52:55], v[180:183], v[120:123], v[52:55]
    ds_read_b64_tr_b16 v[172:173], v19 offset:16384
    ds_read_b64_tr_b16 v[174:175], v19 offset:17408
    v_mfma_f32_16x16x32_bf16 v[84:87], v[180:183], v[124:127], v[84:87]
    s_waitcnt lgkmcnt(10)
    v_mfma_f32_16x16x32_bf16 v[56:59], v[184:187], v[120:123], v[56:59]
    ds_read_b64_tr_b16 v[176:177], v20 offset:16384
    ds_read_b64_tr_b16 v[178:179], v20 offset:17408
    v_mfma_f32_16x16x32_bf16 v[88:91], v[184:187], v[124:127], v[88:91]
    s_waitcnt lgkmcnt(10)
    v_mfma_f32_16x16x32_bf16 v[60:63], v[188:191], v[120:123], v[60:63]
    ds_read_b64_tr_b16 v[180:181], v21 offset:16384
    ds_read_b64_tr_b16 v[182:183], v21 offset:17408
    v_mfma_f32_16x16x32_bf16 v[92:95], v[188:191], v[124:127], v[92:95]
    s_waitcnt vmcnt(6)
    s_waitcnt lgkmcnt(10)
    v_mfma_f32_16x16x32_bf16 v[32:35], v[160:163], v[128:131], v[32:35]
    ds_read_b64_tr_b16 v[184:185], v22 offset:16384
    ds_read_b64_tr_b16 v[186:187], v22 offset:17408
    v_mfma_f32_16x16x32_bf16 v[64:67], v[160:163], v[132:135], v[64:67]
    s_waitcnt lgkmcnt(10)
    v_mfma_f32_16x16x32_bf16 v[36:39], v[164:167], v[128:131], v[36:39]
    ds_read_b64_tr_b16 v[188:189], v23 offset:16384
    ds_read_b64_tr_b16 v[190:191], v23 offset:17408
    v_mfma_f32_16x16x32_bf16 v[68:71], v[164:167], v[132:135], v[68:71]
    s_waitcnt lgkmcnt(10)
    v_mfma_f32_16x16x32_bf16 v[40:43], v[168:171], v[128:131], v[40:43]
    ds_read_b64_tr_b16 v[160:161], v16 offset:24576
    ds_read_b64_tr_b16 v[162:163], v16 offset:25600
    v_mfma_f32_16x16x32_bf16 v[72:75], v[168:171], v[132:135], v[72:75]
    s_waitcnt lgkmcnt(10)
    v_mfma_f32_16x16x32_bf16 v[44:47], v[172:175], v[128:131], v[44:47]
    ds_read_b64_tr_b16 v[164:165], v17 offset:24576
    ds_read_b64_tr_b16 v[166:167], v17 offset:25600
    v_mfma_f32_16x16x32_bf16 v[76:79], v[172:175], v[132:135], v[76:79]
    s_waitcnt lgkmcnt(10)
    v_mfma_f32_16x16x32_bf16 v[48:51], v[176:179], v[128:131], v[48:51]
    ds_read_b64_tr_b16 v[168:169], v18 offset:24576
    ds_read_b64_tr_b16 v[170:171], v18 offset:25600
    v_mfma_f32_16x16x32_bf16 v[80:83], v[176:179], v[132:135], v[80:83]
    s_waitcnt lgkmcnt(10)
    v_mfma_f32_16x16x32_bf16 v[52:55], v[180:183], v[128:131], v[52:55]
    ds_read_b64_tr_b16 v[172:173], v19 offset:24576
    ds_read_b64_tr_b16 v[174:175], v19 offset:25600
    v_mfma_f32_16x16x32_bf16 v[84:87], v[180:183], v[132:135], v[84:87]
    s_waitcnt lgkmcnt(10)
    v_mfma_f32_16x16x32_bf16 v[56:59], v[184:187], v[128:131], v[56:59]
    ds_read_b64_tr_b16 v[176:177], v20 offset:24576
    ds_read_b64_tr_b16 v[178:179], v20 offset:25600
    v_mfma_f32_16x16x32_bf16 v[88:91], v[184:187], v[132:135], v[88:91]
    s_waitcnt lgkmcnt(10)
    v_mfma_f32_16x16x32_bf16 v[60:63], v[188:191], v[128:131], v[60:63]
    ds_read_b64_tr_b16 v[180:181], v21 offset:24576
    ds_read_b64_tr_b16 v[182:183], v21 offset:25600
    v_mfma_f32_16x16x32_bf16 v[92:95], v[188:191], v[132:135], v[92:95]
    s_waitcnt vmcnt(4)
    s_waitcnt lgkmcnt(10)
    v_mfma_f32_16x16x32_bf16 v[32:35], v[160:163], v[136:139], v[32:35]
    ds_read_b64_tr_b16 v[184:185], v22 offset:24576
    ds_read_b64_tr_b16 v[186:187], v22 offset:25600
    v_mfma_f32_16x16x32_bf16 v[64:67], v[160:163], v[140:143], v[64:67]
    s_waitcnt lgkmcnt(10)
    v_mfma_f32_16x16x32_bf16 v[36:39], v[164:167], v[136:139], v[36:39]
    ds_read_b64_tr_b16 v[188:189], v23 offset:24576
    ds_read_b64_tr_b16 v[190:191], v23 offset:25600
    v_mfma_f32_16x16x32_bf16 v[68:71], v[164:167], v[140:143], v[68:71]
    s_waitcnt lgkmcnt(10)
    v_mfma_f32_16x16x32_bf16 v[40:43], v[168:171], v[136:139], v[40:43]
    ds_read_b64_tr_b16 v[160:161], v16 offset:32768
    ds_read_b64_tr_b16 v[162:163], v16 offset:33792
    v_mfma_f32_16x16x32_bf16 v[72:75], v[168:171], v[140:143], v[72:75]
    s_waitcnt lgkmcnt(10)
    v_mfma_f32_16x16x32_bf16 v[44:47], v[172:175], v[136:139], v[44:47]
    ds_read_b64_tr_b16 v[164:165], v17 offset:32768
    ds_read_b64_tr_b16 v[166:167], v17 offset:33792
    v_mfma_f32_16x16x32_bf16 v[76:79], v[172:175], v[140:143], v[76:79]
    s_waitcnt lgkmcnt(10)
    v_mfma_f32_16x16x32_bf16 v[48:51], v[176:179], v[136:139], v[48:51]
    ds_read_b64_tr_b16 v[168:169], v18 offset:32768
    ds_read_b64_tr_b16 v[170:171], v18 offset:33792
    v_mfma_f32_16x16x32_bf16 v[80:83], v[176:179], v[140:143], v[80:83]
    s_waitcnt lgkmcnt(10)
    v_mfma_f32_16x16x32_bf16 v[52:55], v[180:183], v[136:139], v[52:55]
    ds_read_b64_tr_b16 v[172:173], v19 offset:32768
    ds_read_b64_tr_b16 v[174:175], v19 offset:33792
    v_mfma_f32_16x16x32_bf16 v[84:87], v[180:183], v[140:143], v[84:87]
    s_waitcnt lgkmcnt(10)
    v_mfma_f32_16x16x32_bf16 v[56:59], v[184:187], v[136:139], v[56:59]
    ds_read_b64_tr_b16 v[176:177], v20 offset:32768
    ds_read_b64_tr_b16 v[178:179], v20 offset:33792
    v_mfma_f32_16x16x32_bf16 v[88:91], v[184:187], v[140:143], v[88:91]
    s_waitcnt lgkmcnt(10)
    v_mfma_f32_16x16x32_bf16 v[60:63], v[188:191], v[136:139], v[60:63]
    ds_read_b64_tr_b16 v[180:181], v21 offset:32768
    ds_read_b64_tr_b16 v[182:183], v21 offset:33792
    v_mfma_f32_16x16x32_bf16 v[92:95], v[188:191], v[140:143], v[92:95]
    s_waitcnt vmcnt(2)
    s_waitcnt lgkmcnt(10)
    v_mfma_f32_16x16x32_bf16 v[32:35], v[160:163], v[144:147], v[32:35]
    ds_read_b64_tr_b16 v[184:185], v22 offset:32768
    ds_read_b64_tr_b16 v[186:187], v22 offset:33792
    v_mfma_f32_16x16x32_bf16 v[64:67], v[160:163], v[148:151], v[64:67]
    s_waitcnt lgkmcnt(10)
    v_mfma_f32_16x16x32_bf16 v[36:39], v[164:167], v[144:147], v[36:39]
    ds_read_b64_tr_b16 v[188:189], v23 offset:32768
    ds_read_b64_tr_b16 v[190:191], v23 offset:33792
    v_mfma_f32_16x16x32_bf16 v[68:71], v[164:167], v[148:151], v[68:71]
    s_waitcnt lgkmcnt(10)
    v_mfma_f32_16x16x32_bf16 v[40:43], v[168:171], v[144:147], v[40:43]
    ds_read_b64_tr_b16 v[160:161], v16 offset:57344
    ds_read_b64_tr_b16 v[162:163], v16 offset:58368
    v_mfma_f32_16x16x32_bf16 v[72:75], v[168:171], v[148:151], v[72:75]
    s_waitcnt lgkmcnt(10)
    v_mfma_f32_16x16x32_bf16 v[44:47], v[172:175], v[144:147], v[44:47]
    ds_read_b64_tr_b16 v[164:165], v17 offset:57344
    ds_read_b64_tr_b16 v[166:167], v17 offset:58368
    v_mfma_f32_16x16x32_bf16 v[76:79], v[172:175], v[148:151], v[76:79]
    s_waitcnt lgkmcnt(10)
    v_mfma_f32_16x16x32_bf16 v[48:51], v[176:179], v[144:147], v[48:51]
    ds_read_b64_tr_b16 v[168:169], v18 offset:57344
    ds_read_b64_tr_b16 v[170:171], v18 offset:58368
    v_mfma_f32_16x16x32_bf16 v[80:83], v[176:179], v[148:151], v[80:83]
    s_waitcnt lgkmcnt(10)
    v_mfma_f32_16x16x32_bf16 v[52:55], v[180:183], v[144:147], v[52:55]
    ds_read_b64_tr_b16 v[172:173], v19 offset:57344
    ds_read_b64_tr_b16 v[174:175], v19 offset:58368
    v_mfma_f32_16x16x32_bf16 v[84:87], v[180:183], v[148:151], v[84:87]
    s_waitcnt lgkmcnt(10)
    v_mfma_f32_16x16x32_bf16 v[56:59], v[184:187], v[144:147], v[56:59]
    ds_read_b64_tr_b16 v[176:177], v20 offset:57344
    ds_read_b64_tr_b16 v[178:179], v20 offset:58368
    v_mfma_f32_16x16x32_bf16 v[88:91], v[184:187], v[148:151], v[88:91]
    s_waitcnt lgkmcnt(10)
    v_mfma_f32_16x16x32_bf16 v[60:63], v[188:191], v[144:147], v[60:63]
    ds_read_b64_tr_b16 v[180:181], v21 offset:57344
    ds_read_b64_tr_b16 v[182:183], v21 offset:58368
    v_mfma_f32_16x16x32_bf16 v[92:95], v[188:191], v[148:151], v[92:95]
    s_waitcnt vmcnt(0)
    s_waitcnt lgkmcnt(10)
    v_mfma_f32_16x16x32_bf16 v[32:35], v[160:163], v[152:155], v[32:35]
    ds_read_b64_tr_b16 v[184:185], v22 offset:57344
    ds_read_b64_tr_b16 v[186:187], v22 offset:58368
    v_mfma_f32_16x16x32_bf16 v[64:67], v[160:163], v[156:159], v[64:67]
    s_waitcnt lgkmcnt(10)
    v_mfma_f32_16x16x32_bf16 v[36:39], v[164:167], v[152:155], v[36:39]
    ds_read_b64_tr_b16 v[188:189], v23 offset:57344
    ds_read_b64_tr_b16 v[190:191], v23 offset:58368
    v_mfma_f32_16x16x32_bf16 v[68:71], v[164:167], v[156:159], v[68:71]
    s_waitcnt lgkmcnt(10)
    v_mfma_f32_16x16x32_bf16 v[40:43], v[168:171], v[152:155], v[40:43]
    v_mfma_f32_16x16x32_bf16 v[72:75], v[168:171], v[156:159], v[72:75]
    s_waitcnt lgkmcnt(8)
    v_mfma_f32_16x16x32_bf16 v[44:47], v[172:175], v[152:155], v[44:47]
    v_mfma_f32_16x16x32_bf16 v[76:79], v[172:175], v[156:159], v[76:79]
    s_waitcnt lgkmcnt(6)
    v_mfma_f32_16x16x32_bf16 v[48:51], v[176:179], v[152:155], v[48:51]
    v_mfma_f32_16x16x32_bf16 v[80:83], v[176:179], v[156:159], v[80:83]
    s_waitcnt lgkmcnt(4)
    v_mfma_f32_16x16x32_bf16 v[52:55], v[180:183], v[152:155], v[52:55]
    v_mfma_f32_16x16x32_bf16 v[84:87], v[180:183], v[156:159], v[84:87]
    s_waitcnt lgkmcnt(2)
    v_mfma_f32_16x16x32_bf16 v[56:59], v[184:187], v[152:155], v[56:59]
    v_mfma_f32_16x16x32_bf16 v[88:91], v[184:187], v[156:159], v[88:91]
    s_waitcnt lgkmcnt(0)
    v_mfma_f32_16x16x32_bf16 v[60:63], v[188:191], v[152:155], v[60:63]
    v_mfma_f32_16x16x32_bf16 v[92:95], v[188:191], v[156:159], v[92:95]
    s_nop 3
    v_cvt_pk_bf16_f32 v96, v32, v33
    v_cvt_pk_bf16_f32 v97, v34, v35
    ds_write_b64 v235, v[96:97] offset:0
    v_cvt_pk_bf16_f32 v98, v36, v37
    v_cvt_pk_bf16_f32 v99, v38, v39
    ds_write_b64 v236, v[98:99] offset:0
    v_cvt_pk_bf16_f32 v100, v40, v41
    v_cvt_pk_bf16_f32 v101, v42, v43
    ds_write_b64 v237, v[100:101] offset:0
    v_cvt_pk_bf16_f32 v102, v44, v45
    v_cvt_pk_bf16_f32 v103, v46, v47
    ds_write_b64 v238, v[102:103] offset:0
    v_cvt_pk_bf16_f32 v104, v48, v49
    v_cvt_pk_bf16_f32 v105, v50, v51
    ds_write_b64 v239, v[104:105] offset:0
    v_cvt_pk_bf16_f32 v106, v52, v53
    v_cvt_pk_bf16_f32 v107, v54, v55
    ds_write_b64 v240, v[106:107] offset:0
    v_cvt_pk_bf16_f32 v108, v56, v57
    v_cvt_pk_bf16_f32 v109, v58, v59
    ds_write_b64 v241, v[108:109] offset:0
    v_cvt_pk_bf16_f32 v110, v60, v61
    v_cvt_pk_bf16_f32 v111, v62, v63
    ds_write_b64 v242, v[110:111] offset:0
    ds_read_b128 v[128:131], v243 offset:0
    ds_read_b128 v[132:135], v244 offset:1024
    ds_read_b128 v[136:139], v245 offset:2048
    ds_read_b128 v[140:143], v246 offset:3072
    v_cvt_pk_bf16_f32 v112, v64, v65
    v_cvt_pk_bf16_f32 v113, v66, v67
    ds_write_b64 v235, v[112:113] offset:4096
    v_cvt_pk_bf16_f32 v114, v68, v69
    v_cvt_pk_bf16_f32 v115, v70, v71
    ds_write_b64 v236, v[114:115] offset:4096
    v_cvt_pk_bf16_f32 v116, v72, v73
    v_cvt_pk_bf16_f32 v117, v74, v75
    ds_write_b64 v237, v[116:117] offset:4096
    v_cvt_pk_bf16_f32 v118, v76, v77
    v_cvt_pk_bf16_f32 v119, v78, v79
    s_waitcnt lgkmcnt(6)
    buffer_store_dwordx4 v[128:131], v247, s[36:39], 0 offen nt
    ds_write_b64 v238, v[118:119] offset:4096
    v_cvt_pk_bf16_f32 v120, v80, v81
    v_cvt_pk_bf16_f32 v121, v82, v83
    v_add_u32 v247, 4096, v247
    s_waitcnt lgkmcnt(6)
    buffer_store_dwordx4 v[132:135], v247, s[36:39], 0 offen nt
    ds_write_b64 v239, v[120:121] offset:4096
    v_cvt_pk_bf16_f32 v122, v84, v85
    v_cvt_pk_bf16_f32 v123, v86, v87
    v_add_u32 v247, 4096, v247
    s_waitcnt lgkmcnt(6)
    buffer_store_dwordx4 v[136:139], v247, s[36:39], 0 offen nt
    ds_write_b64 v240, v[122:123] offset:4096
    v_cvt_pk_bf16_f32 v124, v88, v89
    v_cvt_pk_bf16_f32 v125, v90, v91
    v_add_u32 v247, 4096, v247
    s_waitcnt lgkmcnt(6)
    buffer_store_dwordx4 v[140:143], v247, s[36:39], 0 offen nt
    ds_write_b64 v241, v[124:125] offset:4096
    v_cvt_pk_bf16_f32 v126, v92, v93
    v_cvt_pk_bf16_f32 v127, v94, v95
    ds_write_b64 v242, v[126:127] offset:4096
    ds_read_b128 v[144:147], v243 offset:4096
    ds_read_b128 v[148:151], v244 offset:5120
    ds_read_b128 v[152:155], v245 offset:6144
    ds_read_b128 v[156:159], v246 offset:7168
    v_add_u32 v247, 4096, v247
    s_waitcnt lgkmcnt(3)
    buffer_store_dwordx4 v[144:147], v247, s[36:39], 0 offen nt
    v_add_u32 v247, 4096, v247
    s_waitcnt lgkmcnt(2)
    buffer_store_dwordx4 v[148:151], v247, s[36:39], 0 offen nt
    v_add_u32 v247, 4096, v247
    s_waitcnt lgkmcnt(1)
    buffer_store_dwordx4 v[152:155], v247, s[36:39], 0 offen nt
    v_add_u32 v247, 4096, v247
    s_waitcnt lgkmcnt(0)
    buffer_store_dwordx4 v[156:159], v247, s[36:39], 0 offen nt
L_fin:
L_end:
    s_endpgm
.section .rodata,"a"
.p2align 6
.amdhsa_kernel standalone__conformer_conv_module__speech_kernel
  .amdhsa_next_free_vgpr 256
  .amdhsa_next_free_sgpr 102
  .amdhsa_accum_offset 256
  .amdhsa_group_segment_fixed_size 0
  .amdhsa_kernarg_size 56
  .amdhsa_user_sgpr_count 2
  .amdhsa_user_sgpr_kernarg_segment_ptr 1
  .amdhsa_system_sgpr_workgroup_id_x 1
.end_amdhsa_kernel
```
